```python
import torch

def _softmax(x, axis=-1):
    return torch.softmax(x, dim=axis)
def _gelu(x):
    return torch.nn.functional.gelu(x, approximate="tanh")
def _silu(x):
    return torch.nn.functional.silu(x)
def _sigmoid(x):
    return torch.sigmoid(x)
def _layernorm(x, axis=-1, eps=1e-5):
    m = x.mean(dim=axis, keepdim=True)
    v = x.var(dim=axis, keepdim=True, unbiased=False)
    return (x - m) / torch.sqrt(v + eps)
def _scatter_add(tgt, idx, src, axis=0):
    return tgt.clone().index_add_(axis, idx, src)
def _segment_sum(src, seg, n):
    out = torch.zeros((n,) + src.shape[1:], dtype=src.dtype)
    return out.index_add_(0, seg, src)
def _pad(x, pw):
    flat = tuple(v for pair in reversed(pw) for v in pair)
    return torch.nn.functional.pad(x, flat)

kernel_name = 'concat_heads__gqa_block_cached__mha_block_cached__near_ridge'

def setup_inputs():

    _w = (lambda a: (lambda t: t.to(torch.bfloat16) if t.is_floating_point() else t)(torch.as_tensor(a)))
    def _A_setup():
        B, Sq, D = 16, 32, 1024
        Hq, Hkv, Sk, Dh = 32, 4, 512, 128
        assert Hq % Hkv == 0, (Hq, Hkv)
        return {
            "x": _w((lambda *s: torch.randn(*s, dtype=torch.bfloat16) * 0.8)(B, Sq, D)),
            "k_cache": _w((lambda *s: torch.randn(*s, dtype=torch.bfloat16) * 0.8)(B, Hkv, Sk, Dh)),
            "v_cache": _w((lambda *s: torch.randn(*s, dtype=torch.bfloat16) * 0.05)(B, Hkv, Sk, Dh)),
            "wq": _w((lambda *s: torch.randn(*s, dtype=torch.bfloat16) * 0.8)(D, Hq * Dh) * (D ** -0.5)),
            "wo": _w((lambda *s: torch.randn(*s, dtype=torch.bfloat16) * 0.05)(Hq * Dh, D) * ((Hq * Dh) ** -0.5)),
        }
    _A_in = _A_setup()

    def _B_setup():
        B, Sq, D = 16, 32, 1024
        H, Sk, Dh = 32, 512, 128
        return {
            "x": _w((lambda *s: torch.randn(*s, dtype=torch.bfloat16) * 0.8)(B, Sq, D)),
            "k_cache": _w((lambda *s: torch.randn(*s, dtype=torch.bfloat16) * 0.8)(B, H, Sk, Dh)),
            "v_cache": _w((lambda *s: torch.randn(*s, dtype=torch.bfloat16) * 0.05)(B, H, Sk, Dh)),
            "wq": _w((lambda *s: torch.randn(*s, dtype=torch.bfloat16) * 0.8)(D, H * Dh) * (D ** -0.5)),
            "wo": _w((lambda *s: torch.randn(*s, dtype=torch.bfloat16) * 0.05)(H * Dh, D) * ((H * Dh) ** -0.5)),
        }
    _B_in = _B_setup()

    return {
        "A_x": _A_in["x"],
        "A_k_cache": _A_in["k_cache"],
        "A_v_cache": _A_in["v_cache"],
        "A_wq": _A_in["wq"],
        "A_wo": _A_in["wo"],
        "B_x": _B_in["x"],
        "B_k_cache": _B_in["k_cache"],
        "B_v_cache": _B_in["v_cache"],
        "B_wq": _B_in["wq"],
        "B_wo": _B_in["wo"],
    }

def reference(A_x, A_k_cache, A_v_cache, A_wq, A_wo, B_x, B_k_cache, B_v_cache, B_wq, B_wo):
    def _A_ref(x, k_cache, v_cache, wq, wo):
        B, Sq, D = x.shape
        Hq, Dh = 32, 128
        Hkv = k_cache.shape[1]
        rep = Hq // Hkv
        q = (lambda x, *d: x.permute(*d))((x @ wq).reshape(B, Sq, Hq, Dh), 0, 2, 1, 3)
        k = (lambda x, n, axis: torch.repeat_interleave(x, n, dim=axis))(k_cache, rep, axis=1)
        v = (lambda x, n, axis: torch.repeat_interleave(x, n, dim=axis))(v_cache, rep, axis=1)
        scores = torch.einsum("bhqd,bhkd->bhqk", q, k) * (Dh ** -0.5)
        p = _softmax(scores, axis=-1)
        o = torch.einsum("bhqk,bhkd->bhqd", p, v)
        return (lambda x, *d: x.permute(*d))(o, 0, 2, 1, 3).reshape(B, Sq, Hq * Dh) @ wo

    def _B_ref(x, k_cache, v_cache, wq, wo):
        B, Sq, D = x.shape
        H, Dh = 32, 128
        q = (lambda x, *d: x.permute(*d))((x @ wq).reshape(B, Sq, H, Dh), 0, 2, 1, 3)
        scores = torch.einsum("bhqd,bhkd->bhqk", q, k_cache) * (Dh ** -0.5)
        p = _softmax(scores, axis=-1)
        o = torch.einsum("bhqk,bhkd->bhqd", p, v_cache)
        return (lambda x, *d: x.permute(*d))(o, 0, 2, 1, 3).reshape(B, Sq, H * Dh) @ wo

    a = _A_ref(A_x, A_k_cache, A_v_cache, A_wq, A_wo)
    b = _B_ref(B_x, B_k_cache, B_v_cache, B_wq, B_wo)
    return torch.concatenate([a, b], axis=-1)
```

```asm
; @launch grid=(256,1,1) block=(512,1,1) lds=163840
.amdgcn_target "amdgcn-amd-amdhsa--gfx950"
.text
.globl concat_heads__gqa_block_cached__mha_block_cached__near_ridge_kernel
.p2align 8
.type concat_heads__gqa_block_cached__mha_block_cached__near_ridge_kernel,@function
concat_heads__gqa_block_cached__mha_block_cached__near_ridge_kernel:
  s_cmp_ge_u32 s2, 256
  s_cbranch_scc1 L_k1_end
  s_load_dwordx16 s[16:31], s[0:1], 0
  s_load_dwordx8 s[32:39], s[0:1], 64
  s_load_dwordx2 s[40:41], s[0:1], 96
  v_lshrrev_b32 v1, 6, v0
  v_and_b32 v0, 63, v0
  s_nop 0
  v_readfirstlane_b32 s3, v1
  s_and_b32 s7, s2, 7
  s_lshr_b32 s8, s2, 3
  s_and_b32 s4, s3, 3
  s_lshr_b32 s5, s3, 2
  s_mov_b32 s76, 0x3e0293ee
  s_lshl_b32 s83, s4, 12
  s_lshl_b32 s84, s4, 11
  s_lshr_b32 s9, s7, 1
  s_lshl_b32 s9, s9, 3
  s_and_b32 s77, s8, 7
  s_add_u32 s9, s9, s77
  s_and_b32 s10, s7, 1
  s_lshl_b32 s10, s10, 2
  s_lshr_b32 s77, s8, 3
  s_add_u32 s10, s10, s77
  s_lshl_b32 s11, s7, 2
  s_and_b32 s77, s8, 3
  s_add_u32 s11, s11, s77
  s_lshr_b32 s12, s8, 2
  v_lshlrev_b32 v5, 4, v0
  v_lshrrev_b32 v64, 4, v0
  v_and_b32 v65, 15, v0
  v_lshlrev_b32 v66, 2, v64
  v_xor_b32 v65, v65, v66
  v_lshlrev_b32 v65, 4, v65
  v_lshlrev_b32 v66, 8, v64
  v_add_u32 v6, v65, v66
  v_xor_b32 v7, 16, v6
  v_xor_b32 v8, 32, v6
  v_xor_b32 v9, 48, v6
  v_lshlrev_b32 v66, 13, v64
  v_add_u32 v80, v65, v66
  v_xor_b32 v81, 16, v80
  v_add_u32 v81, 31744, v81
  v_xor_b32 v82, 32, v80
  v_add_u32 v82, 63488, v82
  v_xor_b32 v83, 48, v80
  v_add_u32 v83, 95232, v83
  v_lshrrev_b32 v66, 3, v0
  v_lshlrev_b32 v66, 11, v66
  v_and_b32 v67, 7, v0
  v_xor_b32 v67, v67, v64
  v_lshlrev_b32 v67, 4, v67
  v_add_u32 v84, v66, v67
  v_xor_b32 v85, 64, v84
  v_add_u32 v85, 15360, v85
  v_and_b32 v66, 31, v0
  v_lshrrev_b32 v67, 5, v0
  v_lshrrev_b32 v68, 1, v66
  v_and_b32 v68, 7, v68
  v_xor_b32 v68, v68, v67
  v_lshlrev_b32 v68, 4, v68
  v_lshlrev_b32 v69, 7, v66
  v_add_u32 v68, v68, v69
  v_mov_b32 v100, v68
  v_xor_b32 v101, 32, v100
  v_xor_b32 v102, 64, v100
  v_xor_b32 v103, 96, v100
  v_add_u32 v104, 65536, v100
  v_add_u32 v105, 65536, v101
  v_add_u32 v106, 65536, v102
  v_add_u32 v107, 65536, v103
  v_and_b32 v68, 3, v66
  v_lshlrev_b32 v68, 2, v68
  v_lshrrev_b32 v69, 2, v66
  v_and_b32 v69, 3, v69
  v_or_b32 v68, v68, v69
  v_xor_b32 v68, v68, v67
  v_lshlrev_b32 v68, 4, v68
  v_lshlrev_b32 v69, 8, v66
  v_add_u32 v10, v68, v69
  v_xor_b32 v11, 32, v10
  v_xor_b32 v12, 64, v10
  v_xor_b32 v13, 96, v10
  v_xor_b32 v14, 128, v10
  v_xor_b32 v15, 160, v10
  v_xor_b32 v16, 192, v10
  v_xor_b32 v17, 224, v10
  v_and_b32 v65, 1, v64
  v_lshrrev_b32 v66, 2, v0
  v_and_b32 v66, 3, v66
  v_and_b32 v68, 1, v0
  v_lshrrev_b32 v69, 1, v0
  v_and_b32 v69, 1, v69
  v_lshlrev_b32 v69, 3, v69
  v_lshlrev_b32 v20, 6, v66
  v_add_u32 v69, v69, v20
  v_lshlrev_b32 v1, 1, v68
  v_or_b32 v1, v1, v65
  v_xor_b32 v1, v1, v67
  v_lshlrev_b32 v1, 4, v1
  v_add_u32 v1, v1, v69
  v_lshlrev_b32 v19, 2, v67
  v_add_u32 v19, v19, v66
  v_lshlrev_b32 v19, 8, v19
  v_add_u32 v18, v1, v19
  v_xor_b32 v19, 2080, v18
  v_xor_b32 v20, 64, v18
  v_xor_b32 v21, 2144, v18
  v_xor_b32 v22, 128, v18
  v_xor_b32 v23, 2208, v18
  v_xor_b32 v24, 192, v18
  v_xor_b32 v25, 2272, v18
  v_lshlrev_b32 v1, 1, v65
  v_or_b32 v1, v1, v68
  v_lshlrev_b32 v97, 1, v67
  v_xor_b32 v1, v1, v97
  v_lshlrev_b32 v1, 4, v1
  v_add_u32 v1, v1, v69
  v_lshlrev_b32 v97, 3, v67
  v_add_u32 v97, v97, v66
  v_lshlrev_b32 v97, 8, v97
  v_add_u32 v1, v1, v97
  s_lshl_b32 s77, s4, 6
  v_xor_b32 v1, s77, v1
  v_add_u32 v96, 65536, v1
  v_xor_b32 v97, 1040, v96
  v_add_u32 v98, 65536, v96
  v_add_u32 v99, 65536, v97
  s_lshl_b32 s77, s5, 14
  s_add_u32 s77, s77, s84
  s_add_u32 s77, s77, 98304
  v_add_u32 v86, s77, v5
  v_and_b32 v1, 15, v0
  v_lshrrev_b32 v120, 1, v1
  v_lshlrev_b32 v120, 13, v120
  v_and_b32 v1, 1, v1
  v_lshlrev_b32 v1, 7, v1
  v_add_u32 v120, v120, v1
  v_and_b32 v121, 7, v0
  v_lshlrev_b32 v121, 11, v121
  v_lshlrev_b32 v31, 7, v0
  s_waitcnt lgkmcnt(0)
  s_add_u32 s64, s40, 0x800000
  s_addc_u32 s65, s41, 0
  s_and_b32 s65, s65, 0xffff
  s_mov_b32 s66, 0x10000
  s_mov_b32 s67, 0x20000
  s_mov_b32 s68, s38
  s_and_b32 s69, s39, 0xffff
  s_mov_b32 s70, 0x100
  s_mov_b32 s71, 0x20000
  s_cmp_lg_u32 s3, 7
  s_cbranch_scc1 L_k1_noflag
  s_lshl_b32 s14, s2, 8
  v_mov_b32 v1, 0
  v_lshlrev_b32 v2, 2, v0
  buffer_store_dword v1, v2, s[64:67], s14 offen sc1
  v_mov_b32 v2, 1
  s_waitcnt vmcnt(0)
  s_mov_b64 exec, 1
  buffer_atomic_add v2, v1, s[68:71], 0 offen
  s_mov_b64 exec, -1
L_k1_noflag:
  s_cmp_ge_u32 s3, 4
  s_cbranch_scc1 L_k1_B
  s_mov_b32 s44, s26
  s_and_b32 s45, s27, 0xffff
  s_mov_b32 s46, 0x100000
  s_mov_b32 s47, 0x20000
  s_mov_b32 s48, s32
  s_and_b32 s49, s33, 0xffff
  s_mov_b32 s50, 0x800000
  s_mov_b32 s51, 0x20000
  s_lshl_b32 s73, s12, 17
  s_lshl_b32 s77, s4, 15
  s_add_u32 s73, s73, s77
  s_lshl_b32 s72, s11, 8
  s_lshl_b32 s77, s4, 17
  s_add_u32 s72, s72, s77
  s_lshl_b32 s77, s12, 1
  s_and_b32 s78, s8, 3
  s_lshl_b32 s78, s78, 2
  s_add_u32 s77, s77, s78
  s_and_b32 s77, s77, 15
  s_lshl_b32 s80, s77, 19
  s_lshl_b32 s81, s77, 7
  s_add_u32 m0, s84, 16384
  s_add_u32 s77, s73, s81
  buffer_load_dwordx4 v84, s[44:47], s77 offen lds
  buffer_load_dwordx4 v85, s[44:47], s77 offen offset:1024 lds
  s_add_u32 m0, s83, 98304
  s_add_u32 s77, s72, s80
  buffer_load_dwordx4 v80, s[48:51], s77 offen offset:0 lds
  buffer_load_dwordx4 v81, s[48:51], s77 offen offset:1024 lds
  buffer_load_dwordx4 v82, s[48:51], s77 offen offset:2048 lds
  buffer_load_dwordx4 v83, s[48:51], s77 offen offset:3072 lds
  s_add_u32 s81, s81, 128
  s_and_b32 s81, s81, 2047
  s_add_u32 s80, s80, 0x80000
  s_and_b32 s80, s80, 0x7fffff
  s_add_u32 m0, s84, 40960
  s_add_u32 s77, s73, s81
  buffer_load_dwordx4 v84, s[44:47], s77 offen lds
  buffer_load_dwordx4 v85, s[44:47], s77 offen offset:1024 lds
  s_add_u32 m0, s83, 114688
  s_add_u32 s77, s72, s80
  buffer_load_dwordx4 v80, s[48:51], s77 offen offset:0 lds
  buffer_load_dwordx4 v81, s[48:51], s77 offen offset:1024 lds
  buffer_load_dwordx4 v82, s[48:51], s77 offen offset:2048 lds
  buffer_load_dwordx4 v83, s[48:51], s77 offen offset:3072 lds
  s_add_u32 s81, s81, 128
  s_and_b32 s81, s81, 2047
  s_add_u32 s80, s80, 0x80000
  s_and_b32 s80, s80, 0x7fffff
  s_add_u32 m0, s84, 65536
  s_add_u32 s77, s73, s81
  buffer_load_dwordx4 v84, s[44:47], s77 offen lds
  buffer_load_dwordx4 v85, s[44:47], s77 offen offset:1024 lds
  s_add_u32 m0, s83, 131072
  s_add_u32 s77, s72, s80
  buffer_load_dwordx4 v80, s[48:51], s77 offen offset:0 lds
  buffer_load_dwordx4 v81, s[48:51], s77 offen offset:1024 lds
  buffer_load_dwordx4 v82, s[48:51], s77 offen offset:2048 lds
  buffer_load_dwordx4 v83, s[48:51], s77 offen offset:3072 lds
  s_add_u32 s81, s81, 128
  s_and_b32 s81, s81, 2047
  s_add_u32 s80, s80, 0x80000
  s_and_b32 s80, s80, 0x7fffff
  s_mov_b32 s52, s18
  s_and_b32 s53, s19, 0xffff
  s_mov_b32 s54, 0x800000
  s_mov_b32 s55, 0x20000
  s_mov_b32 s56, s20
  s_and_b32 s57, s21, 0xffff
  s_mov_b32 s58, 0x800000
  s_mov_b32 s59, 0x20000
  s_mov_b32 s60, s40
  s_and_b32 s61, s41, 0xffff
  s_mov_b32 s62, 0x400000
  s_mov_b32 s63, 0x20000
  s_lshl_b32 s77, s10, 1
  s_lshr_b32 s78, s4, 1
  s_add_u32 s77, s77, s78
  s_lshl_b32 s78, s77, 2
  s_lshr_b32 s79, s9, 3
  s_add_u32 s78, s78, s79
  s_lshl_b32 s74, s78, 17
  s_and_b32 s78, s4, 1
  s_lshl_b32 s78, s78, 16
  s_add_u32 s74, s74, s78
  s_mov_b32 s82, s9
  s_and_b32 s82, s82, 7
  s_lshl_b32 s82, s82, 13
  s_mul_i32 s75, s4, 16384
  s_add_u32 s75, s75, 98304
  v_add_u32 v10, s75, v10
  v_add_u32 v18, s75, v18
  v_add_u32 v11, s75, v11
  v_add_u32 v19, s75, v19
  v_add_u32 v12, s75, v12
  v_add_u32 v20, s75, v20
  v_add_u32 v13, s75, v13
  v_add_u32 v21, s75, v21
  v_add_u32 v14, s75, v14
  v_add_u32 v22, s75, v22
  v_add_u32 v15, s75, v15
  v_add_u32 v23, s75, v23
  v_add_u32 v16, s75, v16
  v_add_u32 v24, s75, v24
  v_add_u32 v17, s75, v17
  v_add_u32 v25, s75, v25
  s_waitcnt vmcnt(12)
  s_barrier
  s_add_u32 m0, s84, 90112
  s_add_u32 s77, s73, s81
  buffer_load_dwordx4 v84, s[44:47], s77 offen lds
  buffer_load_dwordx4 v85, s[44:47], s77 offen offset:1024 lds
  s_add_u32 m0, s83, 147456
  s_add_u32 s77, s72, s80
  buffer_load_dwordx4 v80, s[48:51], s77 offen offset:0 lds
  buffer_load_dwordx4 v81, s[48:51], s77 offen offset:1024 lds
  buffer_load_dwordx4 v82, s[48:51], s77 offen offset:2048 lds
  buffer_load_dwordx4 v83, s[48:51], s77 offen offset:3072 lds
  s_add_u32 s81, s81, 128
  s_and_b32 s81, s81, 2047
  s_add_u32 s80, s80, 0x80000
  s_and_b32 s80, s80, 0x7fffff
  s_waitcnt vmcnt(12)
  s_barrier
  s_add_u32 m0, s84, 16384
  s_add_u32 s77, s73, s81
  buffer_load_dwordx4 v84, s[44:47], s77 offen lds
  buffer_load_dwordx4 v85, s[44:47], s77 offen offset:1024 lds
  s_add_u32 m0, s83, 98304
  s_add_u32 s77, s72, s80
  buffer_load_dwordx4 v80, s[48:51], s77 offen offset:0 lds
  buffer_load_dwordx4 v81, s[48:51], s77 offen offset:1024 lds
  buffer_load_dwordx4 v82, s[48:51], s77 offen offset:2048 lds
  buffer_load_dwordx4 v83, s[48:51], s77 offen offset:3072 lds
  s_add_u32 s81, s81, 128
  s_and_b32 s81, s81, 2047
  s_add_u32 s80, s80, 0x80000
  s_and_b32 s80, s80, 0x7fffff
  s_waitcnt vmcnt(12)
  s_barrier
  s_add_u32 m0, s84, 40960
  s_add_u32 s77, s73, s81
  buffer_load_dwordx4 v84, s[44:47], s77 offen lds
  buffer_load_dwordx4 v85, s[44:47], s77 offen offset:1024 lds
  s_add_u32 m0, s83, 114688
  s_add_u32 s77, s72, s80
  buffer_load_dwordx4 v80, s[48:51], s77 offen offset:0 lds
  buffer_load_dwordx4 v81, s[48:51], s77 offen offset:1024 lds
  buffer_load_dwordx4 v82, s[48:51], s77 offen offset:2048 lds
  buffer_load_dwordx4 v83, s[48:51], s77 offen offset:3072 lds
  s_add_u32 s81, s81, 128
  s_and_b32 s81, s81, 2047
  s_add_u32 s80, s80, 0x80000
  s_and_b32 s80, s80, 0x7fffff
  s_waitcnt vmcnt(12)
  s_barrier
  s_add_u32 m0, s84, 65536
  s_add_u32 s77, s73, s81
  buffer_load_dwordx4 v84, s[44:47], s77 offen lds
  buffer_load_dwordx4 v85, s[44:47], s77 offen offset:1024 lds
  s_add_u32 m0, s83, 131072
  s_add_u32 s77, s72, s80
  buffer_load_dwordx4 v80, s[48:51], s77 offen offset:0 lds
  buffer_load_dwordx4 v81, s[48:51], s77 offen offset:1024 lds
  buffer_load_dwordx4 v82, s[48:51], s77 offen offset:2048 lds
  buffer_load_dwordx4 v83, s[48:51], s77 offen offset:3072 lds
  s_add_u32 s81, s81, 128
  s_and_b32 s81, s81, 2047
  s_add_u32 s80, s80, 0x80000
  s_and_b32 s80, s80, 0x7fffff
  s_waitcnt vmcnt(12)
  s_barrier
  s_add_u32 m0, s84, 90112
  s_add_u32 s77, s73, s81
  buffer_load_dwordx4 v84, s[44:47], s77 offen lds
  buffer_load_dwordx4 v85, s[44:47], s77 offen offset:1024 lds
  s_add_u32 m0, s83, 147456
  s_add_u32 s77, s72, s80
  buffer_load_dwordx4 v80, s[48:51], s77 offen offset:0 lds
  buffer_load_dwordx4 v81, s[48:51], s77 offen offset:1024 lds
  buffer_load_dwordx4 v82, s[48:51], s77 offen offset:2048 lds
  buffer_load_dwordx4 v83, s[48:51], s77 offen offset:3072 lds
  s_add_u32 s81, s81, 128
  s_and_b32 s81, s81, 2047
  s_add_u32 s80, s80, 0x80000
  s_and_b32 s80, s80, 0x7fffff
  s_waitcnt vmcnt(12)
  s_barrier
  s_add_u32 m0, s84, 16384
  s_add_u32 s77, s73, s81
  buffer_load_dwordx4 v84, s[44:47], s77 offen lds
  buffer_load_dwordx4 v85, s[44:47], s77 offen offset:1024 lds
  s_add_u32 m0, s83, 98304
  s_add_u32 s77, s72, s80
  buffer_load_dwordx4 v80, s[48:51], s77 offen offset:0 lds
  buffer_load_dwordx4 v81, s[48:51], s77 offen offset:1024 lds
  buffer_load_dwordx4 v82, s[48:51], s77 offen offset:2048 lds
  buffer_load_dwordx4 v83, s[48:51], s77 offen offset:3072 lds
  s_add_u32 s81, s81, 128
  s_and_b32 s81, s81, 2047
  s_add_u32 s80, s80, 0x80000
  s_and_b32 s80, s80, 0x7fffff
  s_waitcnt vmcnt(12)
  s_barrier
  s_add_u32 m0, s84, 40960
  s_add_u32 s77, s73, s81
  buffer_load_dwordx4 v84, s[44:47], s77 offen lds
  buffer_load_dwordx4 v85, s[44:47], s77 offen offset:1024 lds
  s_add_u32 m0, s83, 114688
  s_add_u32 s77, s72, s80
  buffer_load_dwordx4 v80, s[48:51], s77 offen offset:0 lds
  buffer_load_dwordx4 v81, s[48:51], s77 offen offset:1024 lds
  buffer_load_dwordx4 v82, s[48:51], s77 offen offset:2048 lds
  buffer_load_dwordx4 v83, s[48:51], s77 offen offset:3072 lds
  s_add_u32 s81, s81, 128
  s_and_b32 s81, s81, 2047
  s_add_u32 s80, s80, 0x80000
  s_and_b32 s80, s80, 0x7fffff
  s_waitcnt vmcnt(12)
  s_barrier
  s_add_u32 m0, s84, 65536
  s_add_u32 s77, s73, s81
  buffer_load_dwordx4 v84, s[44:47], s77 offen lds
  buffer_load_dwordx4 v85, s[44:47], s77 offen offset:1024 lds
  s_add_u32 m0, s83, 131072
  s_add_u32 s77, s72, s80
  buffer_load_dwordx4 v80, s[48:51], s77 offen offset:0 lds
  buffer_load_dwordx4 v81, s[48:51], s77 offen offset:1024 lds
  buffer_load_dwordx4 v82, s[48:51], s77 offen offset:2048 lds
  buffer_load_dwordx4 v83, s[48:51], s77 offen offset:3072 lds
  s_add_u32 s81, s81, 128
  s_and_b32 s81, s81, 2047
  s_add_u32 s80, s80, 0x80000
  s_and_b32 s80, s80, 0x7fffff
  s_waitcnt vmcnt(12)
  s_barrier
  s_add_u32 m0, s84, 90112
  s_add_u32 s77, s73, s81
  buffer_load_dwordx4 v84, s[44:47], s77 offen lds
  buffer_load_dwordx4 v85, s[44:47], s77 offen offset:1024 lds
  s_add_u32 m0, s83, 147456
  s_add_u32 s77, s72, s80
  buffer_load_dwordx4 v80, s[48:51], s77 offen offset:0 lds
  buffer_load_dwordx4 v81, s[48:51], s77 offen offset:1024 lds
  buffer_load_dwordx4 v82, s[48:51], s77 offen offset:2048 lds
  buffer_load_dwordx4 v83, s[48:51], s77 offen offset:3072 lds
  s_add_u32 s81, s81, 128
  s_and_b32 s81, s81, 2047
  s_add_u32 s80, s80, 0x80000
  s_and_b32 s80, s80, 0x7fffff
  s_waitcnt vmcnt(12)
  s_barrier
  s_add_u32 m0, s84, 16384
  s_add_u32 s77, s73, s81
  buffer_load_dwordx4 v84, s[44:47], s77 offen lds
  buffer_load_dwordx4 v85, s[44:47], s77 offen offset:1024 lds
  s_add_u32 m0, s83, 98304
  s_add_u32 s77, s72, s80
  buffer_load_dwordx4 v80, s[48:51], s77 offen offset:0 lds
  buffer_load_dwordx4 v81, s[48:51], s77 offen offset:1024 lds
  buffer_load_dwordx4 v82, s[48:51], s77 offen offset:2048 lds
  buffer_load_dwordx4 v83, s[48:51], s77 offen offset:3072 lds
  s_add_u32 s81, s81, 128
  s_and_b32 s81, s81, 2047
  s_add_u32 s80, s80, 0x80000
  s_and_b32 s80, s80, 0x7fffff
  s_waitcnt vmcnt(12)
  s_barrier
  s_add_u32 m0, s84, 40960
  s_add_u32 s77, s73, s81
  buffer_load_dwordx4 v84, s[44:47], s77 offen lds
  buffer_load_dwordx4 v85, s[44:47], s77 offen offset:1024 lds
  s_add_u32 m0, s83, 114688
  s_add_u32 s77, s72, s80
  buffer_load_dwordx4 v80, s[48:51], s77 offen offset:0 lds
  buffer_load_dwordx4 v81, s[48:51], s77 offen offset:1024 lds
  buffer_load_dwordx4 v82, s[48:51], s77 offen offset:2048 lds
  buffer_load_dwordx4 v83, s[48:51], s77 offen offset:3072 lds
  s_add_u32 s81, s81, 128
  s_and_b32 s81, s81, 2047
  s_add_u32 s80, s80, 0x80000
  s_and_b32 s80, s80, 0x7fffff
  s_waitcnt vmcnt(12)
  s_barrier
  s_add_u32 m0, s84, 65536
  s_add_u32 s77, s73, s81
  buffer_load_dwordx4 v84, s[44:47], s77 offen lds
  buffer_load_dwordx4 v85, s[44:47], s77 offen offset:1024 lds
  s_add_u32 m0, s83, 131072
  s_add_u32 s77, s72, s80
  buffer_load_dwordx4 v80, s[48:51], s77 offen offset:0 lds
  buffer_load_dwordx4 v81, s[48:51], s77 offen offset:1024 lds
  buffer_load_dwordx4 v82, s[48:51], s77 offen offset:2048 lds
  buffer_load_dwordx4 v83, s[48:51], s77 offen offset:3072 lds
  s_add_u32 s81, s81, 128
  s_and_b32 s81, s81, 2047
  s_add_u32 s80, s80, 0x80000
  s_and_b32 s80, s80, 0x7fffff
  s_waitcnt vmcnt(12)
  s_barrier
  s_add_u32 m0, s84, 90112
  s_add_u32 s77, s73, s81
  buffer_load_dwordx4 v84, s[44:47], s77 offen lds
  buffer_load_dwordx4 v85, s[44:47], s77 offen offset:1024 lds
  s_add_u32 m0, s83, 147456
  s_add_u32 s77, s72, s80
  buffer_load_dwordx4 v80, s[48:51], s77 offen offset:0 lds
  buffer_load_dwordx4 v81, s[48:51], s77 offen offset:1024 lds
  buffer_load_dwordx4 v82, s[48:51], s77 offen offset:2048 lds
  buffer_load_dwordx4 v83, s[48:51], s77 offen offset:3072 lds
  s_add_u32 s81, s81, 128
  s_and_b32 s81, s81, 2047
  s_add_u32 s80, s80, 0x80000
  s_and_b32 s80, s80, 0x7fffff
  s_waitcnt vmcnt(12)
  s_barrier
  s_mov_b32 s44, s16
  s_and_b32 s45, s17, 0xffff
  s_mov_b32 s46, 0x100000
  s_mov_b32 s47, 0x20000
  s_mov_b32 s48, s22
  s_and_b32 s49, s23, 0xffff
  s_mov_b32 s50, 0x800000
  s_mov_b32 s51, 0x20000
  s_lshl_b32 s73, s10, 17
  s_lshl_b32 s77, s4, 15
  s_add_u32 s73, s73, s77
  s_lshl_b32 s72, s9, 8
  s_lshl_b32 s77, s4, 17
  s_add_u32 s72, s72, s77
  s_lshr_b32 s77, s8, 3
  s_lshl_b32 s77, s77, 2
  s_and_b32 s78, s8, 7
  s_lshl_b32 s78, s78, 1
  s_add_u32 s77, s77, s78
  s_and_b32 s77, s77, 15
  s_lshl_b32 s80, s77, 19
  s_lshl_b32 s81, s77, 7
  s_add_u32 m0, s84, 16384
  s_add_u32 s77, s73, s81
  buffer_load_dwordx4 v84, s[44:47], s77 offen lds
  buffer_load_dwordx4 v85, s[44:47], s77 offen offset:1024 lds
  s_add_u32 m0, s83, 98304
  s_add_u32 s77, s72, s80
  buffer_load_dwordx4 v80, s[48:51], s77 offen offset:0 lds
  buffer_load_dwordx4 v81, s[48:51], s77 offen offset:1024 lds
  buffer_load_dwordx4 v82, s[48:51], s77 offen offset:2048 lds
  buffer_load_dwordx4 v83, s[48:51], s77 offen offset:3072 lds
  s_add_u32 s81, s81, 128
  s_and_b32 s81, s81, 2047
  s_add_u32 s80, s80, 0x80000
  s_and_b32 s80, s80, 0x7fffff
  s_waitcnt vmcnt(12)
  s_barrier
  s_add_u32 m0, s84, 40960
  s_add_u32 s77, s73, s81
  buffer_load_dwordx4 v84, s[44:47], s77 offen lds
  buffer_load_dwordx4 v85, s[44:47], s77 offen offset:1024 lds
  s_add_u32 m0, s83, 114688
  s_add_u32 s77, s72, s80
  buffer_load_dwordx4 v80, s[48:51], s77 offen offset:0 lds
  buffer_load_dwordx4 v81, s[48:51], s77 offen offset:1024 lds
  buffer_load_dwordx4 v82, s[48:51], s77 offen offset:2048 lds
  buffer_load_dwordx4 v83, s[48:51], s77 offen offset:3072 lds
  s_add_u32 s81, s81, 128
  s_and_b32 s81, s81, 2047
  s_add_u32 s80, s80, 0x80000
  s_and_b32 s80, s80, 0x7fffff
  s_waitcnt vmcnt(12)
  s_barrier
  s_add_u32 m0, s84, 65536
  s_add_u32 s77, s73, s81
  buffer_load_dwordx4 v84, s[44:47], s77 offen lds
  buffer_load_dwordx4 v85, s[44:47], s77 offen offset:1024 lds
  s_add_u32 m0, s83, 131072
  s_add_u32 s77, s72, s80
  buffer_load_dwordx4 v80, s[48:51], s77 offen offset:0 lds
  buffer_load_dwordx4 v81, s[48:51], s77 offen offset:1024 lds
  buffer_load_dwordx4 v82, s[48:51], s77 offen offset:2048 lds
  buffer_load_dwordx4 v83, s[48:51], s77 offen offset:3072 lds
  s_add_u32 s81, s81, 128
  s_and_b32 s81, s81, 2047
  s_add_u32 s80, s80, 0x80000
  s_and_b32 s80, s80, 0x7fffff
  s_waitcnt vmcnt(12)
  s_barrier
  ds_read_b64_tr_b16 v[128:129], v96 offset:32768
  ds_read_b64_tr_b16 v[130:131], v97 offset:32768
  ds_read_b128 v[132:135], v100 offset:16384
  ds_read_b128 v[136:139], v100 offset:20480
  ds_read_b64_tr_b16 v[140:141], v96 offset:36864
  ds_read_b64_tr_b16 v[142:143], v97 offset:36864
  ds_read_b128 v[144:147], v101 offset:16384
  ds_read_b128 v[148:151], v101 offset:20480
  ds_read_b64_tr_b16 v[152:153], v96 offset:40960
  ds_read_b64_tr_b16 v[154:155], v97 offset:40960
  ds_read_b128 v[156:159], v102 offset:16384
  ds_read_b128 v[160:163], v102 offset:20480
  ds_read_b64_tr_b16 v[164:165], v96 offset:45056
  ds_read_b64_tr_b16 v[166:167], v97 offset:45056
  ds_read_b128 v[168:171], v103 offset:16384
  ds_read_b128 v[172:175], v103 offset:20480
  s_waitcnt lgkmcnt(0)
  s_waitcnt vmcnt(6)
  s_barrier
  v_mfma_f32_32x32x16_bf16 v[224:239], v[128:131], v[132:135], 0
  ds_read_b64_tr_b16 v[176:177], v96 offset:49152
  ds_read_b64_tr_b16 v[178:179], v97 offset:49152
  ds_read_b128 v[180:183], v100 offset:40960
  ds_read_b128 v[184:187], v100 offset:45056
  v_mfma_f32_32x32x16_bf16 v[240:255], v[128:131], v[136:139], 0
  ds_read_b64_tr_b16 v[188:189], v96 offset:53248
  ds_read_b64_tr_b16 v[190:191], v97 offset:53248
  ds_read_b128 v[192:195], v101 offset:40960
  ds_read_b128 v[196:199], v101 offset:45056
  v_mfma_f32_32x32x16_bf16 v[224:239], v[140:143], v[144:147], v[224:239]
  ds_read_b64_tr_b16 v[200:201], v96 offset:57344
  ds_read_b64_tr_b16 v[202:203], v97 offset:57344
  ds_read_b128 v[204:207], v102 offset:40960
  ds_read_b128 v[208:211], v102 offset:45056
  v_mfma_f32_32x32x16_bf16 v[240:255], v[140:143], v[148:151], v[240:255]
  ds_read_b64_tr_b16 v[212:213], v96 offset:61440
  ds_read_b64_tr_b16 v[214:215], v97 offset:61440
  ds_read_b128 v[216:219], v103 offset:40960
  ds_read_b128 v[220:223], v103 offset:45056
  v_mfma_f32_32x32x16_bf16 v[224:239], v[152:155], v[156:159], v[224:239]
  v_mfma_f32_32x32x16_bf16 v[240:255], v[152:155], v[160:163], v[240:255]
  v_mfma_f32_32x32x16_bf16 v[224:239], v[164:167], v[168:171], v[224:239]
  v_mfma_f32_32x32x16_bf16 v[240:255], v[164:167], v[172:175], v[240:255]
  s_waitcnt lgkmcnt(0)
  s_waitcnt vmcnt(0)
  s_barrier
  v_mfma_f32_32x32x16_bf16 v[224:239], v[176:179], v[180:183], v[224:239]
  ds_read_b64_tr_b16 v[128:129], v98 offset:0
  ds_read_b64_tr_b16 v[130:131], v99 offset:0
  ds_read_b128 v[132:135], v104 offset:0
  ds_read_b128 v[136:139], v104 offset:4096
  v_mfma_f32_32x32x16_bf16 v[240:255], v[176:179], v[184:187], v[240:255]
  ds_read_b64_tr_b16 v[140:141], v98 offset:4096
  ds_read_b64_tr_b16 v[142:143], v99 offset:4096
  ds_read_b128 v[144:147], v105 offset:0
  ds_read_b128 v[148:151], v105 offset:4096
  v_mfma_f32_32x32x16_bf16 v[224:239], v[188:191], v[192:195], v[224:239]
  ds_read_b64_tr_b16 v[152:153], v98 offset:8192
  ds_read_b64_tr_b16 v[154:155], v99 offset:8192
  ds_read_b128 v[156:159], v106 offset:0
  ds_read_b128 v[160:163], v106 offset:4096
  v_mfma_f32_32x32x16_bf16 v[240:255], v[188:191], v[196:199], v[240:255]
  ds_read_b64_tr_b16 v[164:165], v98 offset:12288
  ds_read_b64_tr_b16 v[166:167], v99 offset:12288
  ds_read_b128 v[168:171], v107 offset:0
  ds_read_b128 v[172:175], v107 offset:4096
  v_mfma_f32_32x32x16_bf16 v[224:239], v[200:203], v[204:207], v[224:239]
  v_mfma_f32_32x32x16_bf16 v[240:255], v[200:203], v[208:211], v[240:255]
  v_mfma_f32_32x32x16_bf16 v[224:239], v[212:215], v[216:219], v[224:239]
  v_mfma_f32_32x32x16_bf16 v[240:255], v[212:215], v[220:223], v[240:255]
  s_waitcnt lgkmcnt(0)
  s_barrier
  v_mfma_f32_32x32x16_bf16 v[224:239], v[128:131], v[132:135], v[224:239]
  ds_read_b64_tr_b16 v[176:177], v98 offset:16384
  ds_read_b64_tr_b16 v[178:179], v99 offset:16384
  ds_read_b128 v[180:183], v104 offset:24576
  ds_read_b128 v[184:187], v104 offset:28672
  v_mfma_f32_32x32x16_bf16 v[240:255], v[128:131], v[136:139], v[240:255]
  ds_read_b64_tr_b16 v[188:189], v98 offset:20480
  ds_read_b64_tr_b16 v[190:191], v99 offset:20480
  ds_read_b128 v[192:195], v105 offset:24576
  ds_read_b128 v[196:199], v105 offset:28672
  v_mfma_f32_32x32x16_bf16 v[224:239], v[140:143], v[144:147], v[224:239]
  ds_read_b64_tr_b16 v[200:201], v98 offset:24576
  ds_read_b64_tr_b16 v[202:203], v99 offset:24576
  ds_read_b128 v[204:207], v106 offset:24576
  ds_read_b128 v[208:211], v106 offset:28672
  v_mfma_f32_32x32x16_bf16 v[240:255], v[140:143], v[148:151], v[240:255]
  ds_read_b64_tr_b16 v[212:213], v98 offset:28672
  ds_read_b64_tr_b16 v[214:215], v99 offset:28672
  ds_read_b128 v[216:219], v107 offset:24576
  ds_read_b128 v[220:223], v107 offset:28672
  v_mfma_f32_32x32x16_bf16 v[224:239], v[152:155], v[156:159], v[224:239]
  v_mfma_f32_32x32x16_bf16 v[240:255], v[152:155], v[160:163], v[240:255]
  v_mfma_f32_32x32x16_bf16 v[224:239], v[164:167], v[168:171], v[224:239]
  v_mfma_f32_32x32x16_bf16 v[240:255], v[164:167], v[172:175], v[240:255]
  s_waitcnt lgkmcnt(0)
  s_barrier
  v_mfma_f32_32x32x16_bf16 v[224:239], v[176:179], v[180:183], v[224:239]
  ds_read_b64_tr_b16 v[128:129], v96 offset:32768
  ds_read_b64_tr_b16 v[130:131], v97 offset:32768
  ds_read_b128 v[132:135], v100 offset:16384
  ds_read_b128 v[136:139], v100 offset:20480
  v_mfma_f32_32x32x16_bf16 v[240:255], v[176:179], v[184:187], v[240:255]
  ds_read_b64_tr_b16 v[140:141], v96 offset:36864
  ds_read_b64_tr_b16 v[142:143], v97 offset:36864
  ds_read_b128 v[144:147], v101 offset:16384
  ds_read_b128 v[148:151], v101 offset:20480
  v_mfma_f32_32x32x16_bf16 v[224:239], v[188:191], v[192:195], v[224:239]
  ds_read_b64_tr_b16 v[152:153], v96 offset:40960
  ds_read_b64_tr_b16 v[154:155], v97 offset:40960
  ds_read_b128 v[156:159], v102 offset:16384
  ds_read_b128 v[160:163], v102 offset:20480
  v_mfma_f32_32x32x16_bf16 v[240:255], v[188:191], v[196:199], v[240:255]
  ds_read_b64_tr_b16 v[164:165], v96 offset:45056
  ds_read_b64_tr_b16 v[166:167], v97 offset:45056
  ds_read_b128 v[168:171], v103 offset:16384
  ds_read_b128 v[172:175], v103 offset:20480
  v_mfma_f32_32x32x16_bf16 v[224:239], v[200:203], v[204:207], v[224:239]
  v_mfma_f32_32x32x16_bf16 v[240:255], v[200:203], v[208:211], v[240:255]
  v_mfma_f32_32x32x16_bf16 v[224:239], v[212:215], v[216:219], v[224:239]
  v_mfma_f32_32x32x16_bf16 v[240:255], v[212:215], v[220:223], v[240:255]
  s_waitcnt lgkmcnt(0)
  s_barrier
  v_mfma_f32_32x32x16_bf16 v[224:239], v[128:131], v[132:135], v[224:239]
  ds_read_b64_tr_b16 v[176:177], v96 offset:49152
  ds_read_b64_tr_b16 v[178:179], v97 offset:49152
  ds_read_b128 v[180:183], v100 offset:40960
  ds_read_b128 v[184:187], v100 offset:45056
  v_mfma_f32_32x32x16_bf16 v[240:255], v[128:131], v[136:139], v[240:255]
  ds_read_b64_tr_b16 v[188:189], v96 offset:53248
  ds_read_b64_tr_b16 v[190:191], v97 offset:53248
  ds_read_b128 v[192:195], v101 offset:40960
  ds_read_b128 v[196:199], v101 offset:45056
  v_mfma_f32_32x32x16_bf16 v[224:239], v[140:143], v[144:147], v[224:239]
  ds_read_b64_tr_b16 v[200:201], v96 offset:57344
  ds_read_b64_tr_b16 v[202:203], v97 offset:57344
  ds_read_b128 v[204:207], v102 offset:40960
  ds_read_b128 v[208:211], v102 offset:45056
  v_mfma_f32_32x32x16_bf16 v[240:255], v[140:143], v[148:151], v[240:255]
  ds_read_b64_tr_b16 v[212:213], v96 offset:61440
  ds_read_b64_tr_b16 v[214:215], v97 offset:61440
  ds_read_b128 v[216:219], v103 offset:40960
  ds_read_b128 v[220:223], v103 offset:45056
  v_mfma_f32_32x32x16_bf16 v[224:239], v[152:155], v[156:159], v[224:239]
  v_mfma_f32_32x32x16_bf16 v[240:255], v[152:155], v[160:163], v[240:255]
  v_mfma_f32_32x32x16_bf16 v[224:239], v[164:167], v[168:171], v[224:239]
  v_mfma_f32_32x32x16_bf16 v[240:255], v[164:167], v[172:175], v[240:255]
  s_waitcnt lgkmcnt(0)
  s_barrier
  v_mfma_f32_32x32x16_bf16 v[224:239], v[176:179], v[180:183], v[224:239]
  ds_read_b64_tr_b16 v[128:129], v98 offset:0
  ds_read_b64_tr_b16 v[130:131], v99 offset:0
  ds_read_b128 v[132:135], v104 offset:0
  ds_read_b128 v[136:139], v104 offset:4096
  v_mfma_f32_32x32x16_bf16 v[240:255], v[176:179], v[184:187], v[240:255]
  ds_read_b64_tr_b16 v[140:141], v98 offset:4096
  ds_read_b64_tr_b16 v[142:143], v99 offset:4096
  ds_read_b128 v[144:147], v105 offset:0
  ds_read_b128 v[148:151], v105 offset:4096
  v_mfma_f32_32x32x16_bf16 v[224:239], v[188:191], v[192:195], v[224:239]
  ds_read_b64_tr_b16 v[152:153], v98 offset:8192
  ds_read_b64_tr_b16 v[154:155], v99 offset:8192
  ds_read_b128 v[156:159], v106 offset:0
  ds_read_b128 v[160:163], v106 offset:4096
  v_mfma_f32_32x32x16_bf16 v[240:255], v[188:191], v[196:199], v[240:255]
  ds_read_b64_tr_b16 v[164:165], v98 offset:12288
  ds_read_b64_tr_b16 v[166:167], v99 offset:12288
  ds_read_b128 v[168:171], v107 offset:0
  ds_read_b128 v[172:175], v107 offset:4096
  v_mfma_f32_32x32x16_bf16 v[224:239], v[200:203], v[204:207], v[224:239]
  v_mfma_f32_32x32x16_bf16 v[240:255], v[200:203], v[208:211], v[240:255]
  v_mfma_f32_32x32x16_bf16 v[224:239], v[212:215], v[216:219], v[224:239]
  v_mfma_f32_32x32x16_bf16 v[240:255], v[212:215], v[220:223], v[240:255]
  s_waitcnt lgkmcnt(0)
  s_barrier
  v_mfma_f32_32x32x16_bf16 v[224:239], v[128:131], v[132:135], v[224:239]
  ds_read_b64_tr_b16 v[176:177], v98 offset:16384
  ds_read_b64_tr_b16 v[178:179], v99 offset:16384
  ds_read_b128 v[180:183], v104 offset:24576
  ds_read_b128 v[184:187], v104 offset:28672
  v_mfma_f32_32x32x16_bf16 v[240:255], v[128:131], v[136:139], v[240:255]
  ds_read_b64_tr_b16 v[188:189], v98 offset:20480
  ds_read_b64_tr_b16 v[190:191], v99 offset:20480
  ds_read_b128 v[192:195], v105 offset:24576
  ds_read_b128 v[196:199], v105 offset:28672
  v_mfma_f32_32x32x16_bf16 v[224:239], v[140:143], v[144:147], v[224:239]
  ds_read_b64_tr_b16 v[200:201], v98 offset:24576
  ds_read_b64_tr_b16 v[202:203], v99 offset:24576
  ds_read_b128 v[204:207], v106 offset:24576
  ds_read_b128 v[208:211], v106 offset:28672
  v_mfma_f32_32x32x16_bf16 v[240:255], v[140:143], v[148:151], v[240:255]
  ds_read_b64_tr_b16 v[212:213], v98 offset:28672
  ds_read_b64_tr_b16 v[214:215], v99 offset:28672
  ds_read_b128 v[216:219], v107 offset:24576
  ds_read_b128 v[220:223], v107 offset:28672
  v_mfma_f32_32x32x16_bf16 v[224:239], v[152:155], v[156:159], v[224:239]
  v_mfma_f32_32x32x16_bf16 v[240:255], v[152:155], v[160:163], v[240:255]
  v_mfma_f32_32x32x16_bf16 v[224:239], v[164:167], v[168:171], v[224:239]
  v_mfma_f32_32x32x16_bf16 v[240:255], v[164:167], v[172:175], v[240:255]
  s_waitcnt lgkmcnt(0)
  s_barrier
  v_mfma_f32_32x32x16_bf16 v[224:239], v[176:179], v[180:183], v[224:239]
  ds_read_b64_tr_b16 v[128:129], v96 offset:32768
  ds_read_b64_tr_b16 v[130:131], v97 offset:32768
  ds_read_b128 v[132:135], v100 offset:16384
  ds_read_b128 v[136:139], v100 offset:20480
  v_mfma_f32_32x32x16_bf16 v[240:255], v[176:179], v[184:187], v[240:255]
  ds_read_b64_tr_b16 v[140:141], v96 offset:36864
  ds_read_b64_tr_b16 v[142:143], v97 offset:36864
  ds_read_b128 v[144:147], v101 offset:16384
  ds_read_b128 v[148:151], v101 offset:20480
  v_mfma_f32_32x32x16_bf16 v[224:239], v[188:191], v[192:195], v[224:239]
  ds_read_b64_tr_b16 v[152:153], v96 offset:40960
  ds_read_b64_tr_b16 v[154:155], v97 offset:40960
  ds_read_b128 v[156:159], v102 offset:16384
  ds_read_b128 v[160:163], v102 offset:20480
  v_mfma_f32_32x32x16_bf16 v[240:255], v[188:191], v[196:199], v[240:255]
  ds_read_b64_tr_b16 v[164:165], v96 offset:45056
  ds_read_b64_tr_b16 v[166:167], v97 offset:45056
  ds_read_b128 v[168:171], v103 offset:16384
  ds_read_b128 v[172:175], v103 offset:20480
  v_mfma_f32_32x32x16_bf16 v[224:239], v[200:203], v[204:207], v[224:239]
  v_mfma_f32_32x32x16_bf16 v[240:255], v[200:203], v[208:211], v[240:255]
  v_mfma_f32_32x32x16_bf16 v[224:239], v[212:215], v[216:219], v[224:239]
  v_mfma_f32_32x32x16_bf16 v[240:255], v[212:215], v[220:223], v[240:255]
  s_waitcnt lgkmcnt(0)
  s_barrier
  v_mfma_f32_32x32x16_bf16 v[224:239], v[128:131], v[132:135], v[224:239]
  ds_read_b64_tr_b16 v[176:177], v96 offset:49152
  ds_read_b64_tr_b16 v[178:179], v97 offset:49152
  ds_read_b128 v[180:183], v100 offset:40960
  ds_read_b128 v[184:187], v100 offset:45056
  v_mfma_f32_32x32x16_bf16 v[240:255], v[128:131], v[136:139], v[240:255]
  ds_read_b64_tr_b16 v[188:189], v96 offset:53248
  ds_read_b64_tr_b16 v[190:191], v97 offset:53248
  ds_read_b128 v[192:195], v101 offset:40960
  ds_read_b128 v[196:199], v101 offset:45056
  v_mfma_f32_32x32x16_bf16 v[224:239], v[140:143], v[144:147], v[224:239]
  ds_read_b64_tr_b16 v[200:201], v96 offset:57344
  ds_read_b64_tr_b16 v[202:203], v97 offset:57344
  ds_read_b128 v[204:207], v102 offset:40960
  ds_read_b128 v[208:211], v102 offset:45056
  v_mfma_f32_32x32x16_bf16 v[240:255], v[140:143], v[148:151], v[240:255]
  ds_read_b64_tr_b16 v[212:213], v96 offset:61440
  ds_read_b64_tr_b16 v[214:215], v97 offset:61440
  ds_read_b128 v[216:219], v103 offset:40960
  ds_read_b128 v[220:223], v103 offset:45056
  v_mfma_f32_32x32x16_bf16 v[224:239], v[152:155], v[156:159], v[224:239]
  v_mfma_f32_32x32x16_bf16 v[240:255], v[152:155], v[160:163], v[240:255]
  v_mfma_f32_32x32x16_bf16 v[224:239], v[164:167], v[168:171], v[224:239]
  v_mfma_f32_32x32x16_bf16 v[240:255], v[164:167], v[172:175], v[240:255]
  s_waitcnt lgkmcnt(0)
  s_barrier
  v_mfma_f32_32x32x16_bf16 v[224:239], v[176:179], v[180:183], v[224:239]
  ds_read_b64_tr_b16 v[128:129], v98 offset:0
  ds_read_b64_tr_b16 v[130:131], v99 offset:0
  ds_read_b128 v[132:135], v104 offset:0
  ds_read_b128 v[136:139], v104 offset:4096
  v_mfma_f32_32x32x16_bf16 v[240:255], v[176:179], v[184:187], v[240:255]
  ds_read_b64_tr_b16 v[140:141], v98 offset:4096
  ds_read_b64_tr_b16 v[142:143], v99 offset:4096
  ds_read_b128 v[144:147], v105 offset:0
  ds_read_b128 v[148:151], v105 offset:4096
  v_mfma_f32_32x32x16_bf16 v[224:239], v[188:191], v[192:195], v[224:239]
  ds_read_b64_tr_b16 v[152:153], v98 offset:8192
  ds_read_b64_tr_b16 v[154:155], v99 offset:8192
  ds_read_b128 v[156:159], v106 offset:0
  ds_read_b128 v[160:163], v106 offset:4096
  v_mfma_f32_32x32x16_bf16 v[240:255], v[188:191], v[196:199], v[240:255]
  ds_read_b64_tr_b16 v[164:165], v98 offset:12288
  ds_read_b64_tr_b16 v[166:167], v99 offset:12288
  ds_read_b128 v[168:171], v107 offset:0
  ds_read_b128 v[172:175], v107 offset:4096
  v_mfma_f32_32x32x16_bf16 v[224:239], v[200:203], v[204:207], v[224:239]
  v_mfma_f32_32x32x16_bf16 v[240:255], v[200:203], v[208:211], v[240:255]
  v_mfma_f32_32x32x16_bf16 v[224:239], v[212:215], v[216:219], v[224:239]
  v_mfma_f32_32x32x16_bf16 v[240:255], v[212:215], v[220:223], v[240:255]
  s_waitcnt lgkmcnt(0)
  s_barrier
  v_mfma_f32_32x32x16_bf16 v[224:239], v[128:131], v[132:135], v[224:239]
  ds_read_b64_tr_b16 v[176:177], v98 offset:16384
  ds_read_b64_tr_b16 v[178:179], v99 offset:16384
  ds_read_b128 v[180:183], v104 offset:24576
  ds_read_b128 v[184:187], v104 offset:28672
  v_mfma_f32_32x32x16_bf16 v[240:255], v[128:131], v[136:139], v[240:255]
  ds_read_b64_tr_b16 v[188:189], v98 offset:20480
  ds_read_b64_tr_b16 v[190:191], v99 offset:20480
  ds_read_b128 v[192:195], v105 offset:24576
  ds_read_b128 v[196:199], v105 offset:28672
  v_mfma_f32_32x32x16_bf16 v[224:239], v[140:143], v[144:147], v[224:239]
  ds_read_b64_tr_b16 v[200:201], v98 offset:24576
  ds_read_b64_tr_b16 v[202:203], v99 offset:24576
  ds_read_b128 v[204:207], v106 offset:24576
  ds_read_b128 v[208:211], v106 offset:28672
  v_mfma_f32_32x32x16_bf16 v[240:255], v[140:143], v[148:151], v[240:255]
  ds_read_b64_tr_b16 v[212:213], v98 offset:28672
  ds_read_b64_tr_b16 v[214:215], v99 offset:28672
  ds_read_b128 v[216:219], v107 offset:24576
  ds_read_b128 v[220:223], v107 offset:28672
  v_mfma_f32_32x32x16_bf16 v[224:239], v[152:155], v[156:159], v[224:239]
  v_mfma_f32_32x32x16_bf16 v[240:255], v[152:155], v[160:163], v[240:255]
  v_mfma_f32_32x32x16_bf16 v[224:239], v[164:167], v[168:171], v[224:239]
  v_mfma_f32_32x32x16_bf16 v[240:255], v[164:167], v[172:175], v[240:255]
  s_waitcnt lgkmcnt(0)
  s_barrier
  v_mfma_f32_32x32x16_bf16 v[224:239], v[176:179], v[180:183], v[224:239]
  ds_read_b64_tr_b16 v[128:129], v96 offset:32768
  ds_read_b64_tr_b16 v[130:131], v97 offset:32768
  ds_read_b128 v[132:135], v100 offset:16384
  ds_read_b128 v[136:139], v100 offset:20480
  v_mfma_f32_32x32x16_bf16 v[240:255], v[176:179], v[184:187], v[240:255]
  ds_read_b64_tr_b16 v[140:141], v96 offset:36864
  ds_read_b64_tr_b16 v[142:143], v97 offset:36864
  ds_read_b128 v[144:147], v101 offset:16384
  ds_read_b128 v[148:151], v101 offset:20480
  v_mfma_f32_32x32x16_bf16 v[224:239], v[188:191], v[192:195], v[224:239]
  ds_read_b64_tr_b16 v[152:153], v96 offset:40960
  ds_read_b64_tr_b16 v[154:155], v97 offset:40960
  ds_read_b128 v[156:159], v102 offset:16384
  ds_read_b128 v[160:163], v102 offset:20480
  v_mfma_f32_32x32x16_bf16 v[240:255], v[188:191], v[196:199], v[240:255]
  ds_read_b64_tr_b16 v[164:165], v96 offset:45056
  ds_read_b64_tr_b16 v[166:167], v97 offset:45056
  ds_read_b128 v[168:171], v103 offset:16384
  ds_read_b128 v[172:175], v103 offset:20480
  v_mfma_f32_32x32x16_bf16 v[224:239], v[200:203], v[204:207], v[224:239]
  v_mfma_f32_32x32x16_bf16 v[240:255], v[200:203], v[208:211], v[240:255]
  v_mfma_f32_32x32x16_bf16 v[224:239], v[212:215], v[216:219], v[224:239]
  v_mfma_f32_32x32x16_bf16 v[240:255], v[212:215], v[220:223], v[240:255]
  s_waitcnt lgkmcnt(0)
  s_barrier
  v_mfma_f32_32x32x16_bf16 v[224:239], v[128:131], v[132:135], v[224:239]
  ds_read_b64_tr_b16 v[176:177], v96 offset:49152
  ds_read_b64_tr_b16 v[178:179], v97 offset:49152
  ds_read_b128 v[180:183], v100 offset:40960
  ds_read_b128 v[184:187], v100 offset:45056
  v_mfma_f32_32x32x16_bf16 v[240:255], v[128:131], v[136:139], v[240:255]
  ds_read_b64_tr_b16 v[188:189], v96 offset:53248
  ds_read_b64_tr_b16 v[190:191], v97 offset:53248
  ds_read_b128 v[192:195], v101 offset:40960
  ds_read_b128 v[196:199], v101 offset:45056
  v_mfma_f32_32x32x16_bf16 v[224:239], v[140:143], v[144:147], v[224:239]
  ds_read_b64_tr_b16 v[200:201], v96 offset:57344
  ds_read_b64_tr_b16 v[202:203], v97 offset:57344
  ds_read_b128 v[204:207], v102 offset:40960
  ds_read_b128 v[208:211], v102 offset:45056
  v_mfma_f32_32x32x16_bf16 v[240:255], v[140:143], v[148:151], v[240:255]
  ds_read_b64_tr_b16 v[212:213], v96 offset:61440
  ds_read_b64_tr_b16 v[214:215], v97 offset:61440
  ds_read_b128 v[216:219], v103 offset:40960
  ds_read_b128 v[220:223], v103 offset:45056
  v_mfma_f32_32x32x16_bf16 v[224:239], v[152:155], v[156:159], v[224:239]
  v_mfma_f32_32x32x16_bf16 v[240:255], v[152:155], v[160:163], v[240:255]
  v_mfma_f32_32x32x16_bf16 v[224:239], v[164:167], v[168:171], v[224:239]
  v_mfma_f32_32x32x16_bf16 v[240:255], v[164:167], v[172:175], v[240:255]
  s_waitcnt lgkmcnt(0)
  s_barrier
  v_mfma_f32_32x32x16_bf16 v[224:239], v[176:179], v[180:183], v[224:239]
  ds_read_b64_tr_b16 v[128:129], v98 offset:0
  ds_read_b64_tr_b16 v[130:131], v99 offset:0
  ds_read_b128 v[132:135], v104 offset:0
  ds_read_b128 v[136:139], v104 offset:4096
  v_mfma_f32_32x32x16_bf16 v[240:255], v[176:179], v[184:187], v[240:255]
  ds_read_b64_tr_b16 v[140:141], v98 offset:4096
  ds_read_b64_tr_b16 v[142:143], v99 offset:4096
  ds_read_b128 v[144:147], v105 offset:0
  ds_read_b128 v[148:151], v105 offset:4096
  v_mfma_f32_32x32x16_bf16 v[224:239], v[188:191], v[192:195], v[224:239]
  ds_read_b64_tr_b16 v[152:153], v98 offset:8192
  ds_read_b64_tr_b16 v[154:155], v99 offset:8192
  ds_read_b128 v[156:159], v106 offset:0
  ds_read_b128 v[160:163], v106 offset:4096
  v_mfma_f32_32x32x16_bf16 v[240:255], v[188:191], v[196:199], v[240:255]
  ds_read_b64_tr_b16 v[164:165], v98 offset:12288
  ds_read_b64_tr_b16 v[166:167], v99 offset:12288
  ds_read_b128 v[168:171], v107 offset:0
  ds_read_b128 v[172:175], v107 offset:4096
  v_mfma_f32_32x32x16_bf16 v[224:239], v[200:203], v[204:207], v[224:239]
  v_mfma_f32_32x32x16_bf16 v[240:255], v[200:203], v[208:211], v[240:255]
  v_mfma_f32_32x32x16_bf16 v[224:239], v[212:215], v[216:219], v[224:239]
  v_mfma_f32_32x32x16_bf16 v[240:255], v[212:215], v[220:223], v[240:255]
  s_waitcnt lgkmcnt(0)
  s_barrier
  v_mfma_f32_32x32x16_bf16 v[224:239], v[128:131], v[132:135], v[224:239]
  ds_read_b64_tr_b16 v[176:177], v98 offset:16384
  ds_read_b64_tr_b16 v[178:179], v99 offset:16384
  ds_read_b128 v[180:183], v104 offset:24576
  ds_read_b128 v[184:187], v104 offset:28672
  v_mfma_f32_32x32x16_bf16 v[240:255], v[128:131], v[136:139], v[240:255]
  ds_read_b64_tr_b16 v[188:189], v98 offset:20480
  ds_read_b64_tr_b16 v[190:191], v99 offset:20480
  ds_read_b128 v[192:195], v105 offset:24576
  ds_read_b128 v[196:199], v105 offset:28672
  v_mfma_f32_32x32x16_bf16 v[224:239], v[140:143], v[144:147], v[224:239]
  ds_read_b64_tr_b16 v[200:201], v98 offset:24576
  ds_read_b64_tr_b16 v[202:203], v99 offset:24576
  ds_read_b128 v[204:207], v106 offset:24576
  ds_read_b128 v[208:211], v106 offset:28672
  v_mfma_f32_32x32x16_bf16 v[240:255], v[140:143], v[148:151], v[240:255]
  ds_read_b64_tr_b16 v[212:213], v98 offset:28672
  ds_read_b64_tr_b16 v[214:215], v99 offset:28672
  ds_read_b128 v[216:219], v107 offset:24576
  ds_read_b128 v[220:223], v107 offset:28672
  v_mfma_f32_32x32x16_bf16 v[224:239], v[152:155], v[156:159], v[224:239]
  v_mfma_f32_32x32x16_bf16 v[240:255], v[152:155], v[160:163], v[240:255]
  v_mfma_f32_32x32x16_bf16 v[224:239], v[164:167], v[168:171], v[224:239]
  v_mfma_f32_32x32x16_bf16 v[240:255], v[164:167], v[172:175], v[240:255]
  s_waitcnt lgkmcnt(0)
  v_mfma_f32_32x32x16_bf16 v[224:239], v[176:179], v[180:183], v[224:239]
  v_mfma_f32_32x32x16_bf16 v[240:255], v[176:179], v[184:187], v[240:255]
  v_mfma_f32_32x32x16_bf16 v[224:239], v[188:191], v[192:195], v[224:239]
  v_mfma_f32_32x32x16_bf16 v[240:255], v[188:191], v[196:199], v[240:255]
  v_mfma_f32_32x32x16_bf16 v[224:239], v[200:203], v[204:207], v[224:239]
  v_mfma_f32_32x32x16_bf16 v[240:255], v[200:203], v[208:211], v[240:255]
  v_mfma_f32_32x32x16_bf16 v[224:239], v[212:215], v[216:219], v[224:239]
  v_mfma_f32_32x32x16_bf16 v[240:255], v[212:215], v[220:223], v[240:255]
  s_nop 15
  s_nop 3
  v_cvt_pk_bf16_f32 v64, v224, v225
  v_cvt_pk_bf16_f32 v65, v226, v227
  v_cvt_pk_bf16_f32 v66, v228, v229
  v_cvt_pk_bf16_f32 v67, v230, v231
  v_cvt_pk_bf16_f32 v68, v232, v233
  v_cvt_pk_bf16_f32 v69, v234, v235
  v_cvt_pk_bf16_f32 v70, v236, v237
  v_cvt_pk_bf16_f32 v71, v238, v239
  v_cvt_pk_bf16_f32 v72, v240, v241
  v_cvt_pk_bf16_f32 v73, v242, v243
  v_cvt_pk_bf16_f32 v74, v244, v245
  v_cvt_pk_bf16_f32 v75, v246, v247
  v_cvt_pk_bf16_f32 v76, v248, v249
  v_cvt_pk_bf16_f32 v77, v250, v251
  v_cvt_pk_bf16_f32 v78, v252, v253
  v_cvt_pk_bf16_f32 v79, v254, v255
  ds_write_b128 v86, v[64:67] offset:0
  ds_write_b128 v86, v[68:71] offset:1024
  ds_write_b128 v86, v[72:75] offset:8192
  ds_write_b128 v86, v[76:79] offset:9216
  s_lshr_b32 s78, s4, 1
  s_lshl_b32 s78, s78, 13
  s_add_u32 s78, s78, 98304
  v_add_u32 v26, s78, v5
  s_waitcnt lgkmcnt(0)
  s_barrier
  ds_read_b128 v[32:35], v26 offset:0
  ds_read_b128 v[36:39], v26 offset:1024
  ds_read_b128 v[40:43], v26 offset:2048
  ds_read_b128 v[44:47], v26 offset:3072
  ds_read_b128 v[48:51], v26 offset:4096
  ds_read_b128 v[52:55], v26 offset:5120
  ds_read_b128 v[56:59], v26 offset:6144
  ds_read_b128 v[60:63], v26 offset:7168
  s_waitcnt lgkmcnt(0)
  s_barrier
  s_add_u32 s77, s82, 0
  s_and_b32 s77, s77, 0xffff
  s_add_u32 s77, s77, s74
  s_add_u32 m0, s75, 0
  s_nop 0
  buffer_load_dwordx4 v6, s[52:55], s77 offen offset:0 lds
  buffer_load_dwordx4 v7, s[52:55], s77 offen offset:1024 lds
  buffer_load_dwordx4 v8, s[52:55], s77 offen offset:2048 lds
  buffer_load_dwordx4 v9, s[52:55], s77 offen offset:3072 lds
  s_add_u32 m0, s75, 4096
  s_add_u32 s77, s77, 4096
  buffer_load_dwordx4 v6, s[52:55], s77 offen offset:0 lds
  buffer_load_dwordx4 v7, s[52:55], s77 offen offset:1024 lds
  buffer_load_dwordx4 v8, s[52:55], s77 offen offset:2048 lds
  buffer_load_dwordx4 v9, s[52:55], s77 offen offset:3072 lds
  s_add_u32 s77, s82, 8192
  s_and_b32 s77, s77, 0xffff
  s_add_u32 s77, s77, s74
  s_add_u32 m0, s75, 8192
  s_nop 0
  buffer_load_dwordx4 v6, s[52:55], s77 offen offset:0 lds
  buffer_load_dwordx4 v7, s[52:55], s77 offen offset:1024 lds
  buffer_load_dwordx4 v8, s[52:55], s77 offen offset:2048 lds
  buffer_load_dwordx4 v9, s[52:55], s77 offen offset:3072 lds
  s_add_u32 m0, s75, 12288
  s_add_u32 s77, s77, 4096
  buffer_load_dwordx4 v6, s[52:55], s77 offen offset:0 lds
  buffer_load_dwordx4 v7, s[52:55], s77 offen offset:1024 lds
  buffer_load_dwordx4 v8, s[52:55], s77 offen offset:2048 lds
  buffer_load_dwordx4 v9, s[52:55], s77 offen offset:3072 lds
  s_waitcnt vmcnt(8)
  ds_read_b128 v[64:67], v10 offset:0
  ds_read_b128 v[68:71], v11 offset:0
  ds_read_b128 v[72:75], v12 offset:0
  ds_read_b128 v[76:79], v13 offset:0
  ds_read_b128 v[80:83], v14 offset:0
  ds_read_b128 v[84:87], v15 offset:0
  ds_read_b128 v[88:91], v16 offset:0
  ds_read_b128 v[92:95], v17 offset:0
  s_waitcnt lgkmcnt(7)
  v_mfma_f32_32x32x16_bf16 v[128:143], v[64:67], v[32:35], 0
  s_waitcnt lgkmcnt(6)
  v_mfma_f32_32x32x16_bf16 v[128:143], v[68:71], v[36:39], v[128:143]
  s_waitcnt lgkmcnt(5)
  v_mfma_f32_32x32x16_bf16 v[128:143], v[72:75], v[40:43], v[128:143]
  s_waitcnt lgkmcnt(4)
  v_mfma_f32_32x32x16_bf16 v[128:143], v[76:79], v[44:47], v[128:143]
  s_waitcnt lgkmcnt(3)
  v_mfma_f32_32x32x16_bf16 v[128:143], v[80:83], v[48:51], v[128:143]
  s_waitcnt lgkmcnt(2)
  v_mfma_f32_32x32x16_bf16 v[128:143], v[84:87], v[52:55], v[128:143]
  s_waitcnt lgkmcnt(1)
  v_mfma_f32_32x32x16_bf16 v[128:143], v[88:91], v[56:59], v[128:143]
  s_waitcnt lgkmcnt(0)
  v_mfma_f32_32x32x16_bf16 v[128:143], v[92:95], v[60:63], v[128:143]
  s_add_u32 s77, s82, 16384
  s_and_b32 s77, s77, 0xffff
  s_add_u32 s77, s77, s74
  s_add_u32 m0, s75, 0
  s_nop 0
  buffer_load_dwordx4 v6, s[52:55], s77 offen offset:0 lds
  buffer_load_dwordx4 v7, s[52:55], s77 offen offset:1024 lds
  buffer_load_dwordx4 v8, s[52:55], s77 offen offset:2048 lds
  buffer_load_dwordx4 v9, s[52:55], s77 offen offset:3072 lds
  s_add_u32 m0, s75, 4096
  s_add_u32 s77, s77, 4096
  buffer_load_dwordx4 v6, s[52:55], s77 offen offset:0 lds
  buffer_load_dwordx4 v7, s[52:55], s77 offen offset:1024 lds
  buffer_load_dwordx4 v8, s[52:55], s77 offen offset:2048 lds
  buffer_load_dwordx4 v9, s[52:55], s77 offen offset:3072 lds
  s_waitcnt vmcnt(8)
  ds_read_b128 v[64:67], v10 offset:8192
  ds_read_b128 v[68:71], v11 offset:8192
  ds_read_b128 v[72:75], v12 offset:8192
  ds_read_b128 v[76:79], v13 offset:8192
  ds_read_b128 v[80:83], v14 offset:8192
  ds_read_b128 v[84:87], v15 offset:8192
  ds_read_b128 v[88:91], v16 offset:8192
  ds_read_b128 v[92:95], v17 offset:8192
  v_max3_f32 v26, v128, v129, v130
  v_max3_f32 v26, v26, v131, v132
  v_max3_f32 v26, v26, v133, v134
  v_max_f32 v26, v26, v135
  v_max3_f32 v27, v136, v137, v138
  v_max3_f32 v27, v27, v139, v140
  v_max3_f32 v27, v27, v141, v142
  v_max_f32 v27, v27, v143
  s_waitcnt lgkmcnt(7)
  v_mfma_f32_32x32x16_bf16 v[144:159], v[64:67], v[32:35], 0
  s_waitcnt lgkmcnt(6)
  v_mfma_f32_32x32x16_bf16 v[144:159], v[68:71], v[36:39], v[144:159]
  s_waitcnt lgkmcnt(5)
  v_mfma_f32_32x32x16_bf16 v[144:159], v[72:75], v[40:43], v[144:159]
  s_waitcnt lgkmcnt(4)
  v_mfma_f32_32x32x16_bf16 v[144:159], v[76:79], v[44:47], v[144:159]
  s_waitcnt lgkmcnt(3)
  v_mfma_f32_32x32x16_bf16 v[144:159], v[80:83], v[48:51], v[144:159]
  s_waitcnt lgkmcnt(2)
  v_mfma_f32_32x32x16_bf16 v[144:159], v[84:87], v[52:55], v[144:159]
  s_waitcnt lgkmcnt(1)
  v_mfma_f32_32x32x16_bf16 v[144:159], v[88:91], v[56:59], v[144:159]
  s_waitcnt lgkmcnt(0)
  v_mfma_f32_32x32x16_bf16 v[144:159], v[92:95], v[60:63], v[144:159]
  s_add_u32 s77, s82, 24576
  s_and_b32 s77, s77, 0xffff
  s_add_u32 s77, s77, s74
  s_add_u32 m0, s75, 8192
  s_nop 0
  buffer_load_dwordx4 v6, s[52:55], s77 offen offset:0 lds
  buffer_load_dwordx4 v7, s[52:55], s77 offen offset:1024 lds
  buffer_load_dwordx4 v8, s[52:55], s77 offen offset:2048 lds
  buffer_load_dwordx4 v9, s[52:55], s77 offen offset:3072 lds
  s_add_u32 m0, s75, 12288
  s_add_u32 s77, s77, 4096
  buffer_load_dwordx4 v6, s[52:55], s77 offen offset:0 lds
  buffer_load_dwordx4 v7, s[52:55], s77 offen offset:1024 lds
  buffer_load_dwordx4 v8, s[52:55], s77 offen offset:2048 lds
  buffer_load_dwordx4 v9, s[52:55], s77 offen offset:3072 lds
  s_waitcnt vmcnt(8)
  s_barrier
  ds_read_b128 v[64:67], v10 offset:0
  ds_read_b128 v[68:71], v11 offset:0
  ds_read_b128 v[72:75], v12 offset:0
  ds_read_b128 v[76:79], v13 offset:0
  ds_read_b128 v[80:83], v14 offset:0
  ds_read_b128 v[84:87], v15 offset:0
  ds_read_b128 v[88:91], v16 offset:0
  ds_read_b128 v[92:95], v17 offset:0
  v_max3_f32 v26, v26, v144, v145
  v_max3_f32 v26, v26, v146, v147
  v_max3_f32 v26, v26, v148, v149
  v_max3_f32 v26, v26, v150, v151
  v_max3_f32 v27, v27, v152, v153
  v_max3_f32 v27, v27, v154, v155
  v_max3_f32 v27, v27, v156, v157
  v_max3_f32 v27, v27, v158, v159
  s_waitcnt lgkmcnt(7)
  v_mfma_f32_32x32x16_bf16 v[160:175], v[64:67], v[32:35], 0
  s_waitcnt lgkmcnt(6)
  v_mfma_f32_32x32x16_bf16 v[160:175], v[68:71], v[36:39], v[160:175]
  s_waitcnt lgkmcnt(5)
  v_mfma_f32_32x32x16_bf16 v[160:175], v[72:75], v[40:43], v[160:175]
  s_waitcnt lgkmcnt(4)
  v_mfma_f32_32x32x16_bf16 v[160:175], v[76:79], v[44:47], v[160:175]
  s_waitcnt lgkmcnt(3)
  v_mfma_f32_32x32x16_bf16 v[160:175], v[80:83], v[48:51], v[160:175]
  s_waitcnt lgkmcnt(2)
  v_mfma_f32_32x32x16_bf16 v[160:175], v[84:87], v[52:55], v[160:175]
  s_waitcnt lgkmcnt(1)
  v_mfma_f32_32x32x16_bf16 v[160:175], v[88:91], v[56:59], v[160:175]
  s_waitcnt lgkmcnt(0)
  v_mfma_f32_32x32x16_bf16 v[160:175], v[92:95], v[60:63], v[160:175]
  s_add_u32 s77, s82, 32768
  s_and_b32 s77, s77, 0xffff
  s_add_u32 s77, s77, s74
  s_add_u32 m0, s75, 0
  s_nop 0
  buffer_load_dwordx4 v6, s[52:55], s77 offen offset:0 lds
  buffer_load_dwordx4 v7, s[52:55], s77 offen offset:1024 lds
  buffer_load_dwordx4 v8, s[52:55], s77 offen offset:2048 lds
  buffer_load_dwordx4 v9, s[52:55], s77 offen offset:3072 lds
  s_add_u32 m0, s75, 4096
  s_add_u32 s77, s77, 4096
  buffer_load_dwordx4 v6, s[52:55], s77 offen offset:0 lds
  buffer_load_dwordx4 v7, s[52:55], s77 offen offset:1024 lds
  buffer_load_dwordx4 v8, s[52:55], s77 offen offset:2048 lds
  buffer_load_dwordx4 v9, s[52:55], s77 offen offset:3072 lds
  s_waitcnt vmcnt(8)
  s_barrier
  ds_read_b128 v[64:67], v10 offset:8192
  ds_read_b128 v[68:71], v11 offset:8192
  ds_read_b128 v[72:75], v12 offset:8192
  ds_read_b128 v[76:79], v13 offset:8192
  ds_read_b128 v[80:83], v14 offset:8192
  ds_read_b128 v[84:87], v15 offset:8192
  ds_read_b128 v[88:91], v16 offset:8192
  ds_read_b128 v[92:95], v17 offset:8192
  v_max3_f32 v26, v26, v160, v161
  v_max3_f32 v26, v26, v162, v163
  v_max3_f32 v26, v26, v164, v165
  v_max3_f32 v26, v26, v166, v167
  v_max3_f32 v27, v27, v168, v169
  v_max3_f32 v27, v27, v170, v171
  v_max3_f32 v27, v27, v172, v173
  v_max3_f32 v27, v27, v174, v175
  s_waitcnt lgkmcnt(7)
  v_mfma_f32_32x32x16_bf16 v[176:191], v[64:67], v[32:35], 0
  s_waitcnt lgkmcnt(6)
  v_mfma_f32_32x32x16_bf16 v[176:191], v[68:71], v[36:39], v[176:191]
  s_waitcnt lgkmcnt(5)
  v_mfma_f32_32x32x16_bf16 v[176:191], v[72:75], v[40:43], v[176:191]
  s_waitcnt lgkmcnt(4)
  v_mfma_f32_32x32x16_bf16 v[176:191], v[76:79], v[44:47], v[176:191]
  s_waitcnt lgkmcnt(3)
  v_mfma_f32_32x32x16_bf16 v[176:191], v[80:83], v[48:51], v[176:191]
  s_waitcnt lgkmcnt(2)
  v_mfma_f32_32x32x16_bf16 v[176:191], v[84:87], v[52:55], v[176:191]
  s_waitcnt lgkmcnt(1)
  v_mfma_f32_32x32x16_bf16 v[176:191], v[88:91], v[56:59], v[176:191]
  s_waitcnt lgkmcnt(0)
  v_mfma_f32_32x32x16_bf16 v[176:191], v[92:95], v[60:63], v[176:191]
  s_add_u32 s77, s82, 40960
  s_and_b32 s77, s77, 0xffff
  s_add_u32 s77, s77, s74
  s_add_u32 m0, s75, 8192
  s_nop 0
  buffer_load_dwordx4 v6, s[52:55], s77 offen offset:0 lds
  buffer_load_dwordx4 v7, s[52:55], s77 offen offset:1024 lds
  buffer_load_dwordx4 v8, s[52:55], s77 offen offset:2048 lds
  buffer_load_dwordx4 v9, s[52:55], s77 offen offset:3072 lds
  s_add_u32 m0, s75, 12288
  s_add_u32 s77, s77, 4096
  buffer_load_dwordx4 v6, s[52:55], s77 offen offset:0 lds
  buffer_load_dwordx4 v7, s[52:55], s77 offen offset:1024 lds
  buffer_load_dwordx4 v8, s[52:55], s77 offen offset:2048 lds
  buffer_load_dwordx4 v9, s[52:55], s77 offen offset:3072 lds
  s_waitcnt vmcnt(8)
  ds_read_b128 v[64:67], v10 offset:0
  ds_read_b128 v[68:71], v11 offset:0
  ds_read_b128 v[72:75], v12 offset:0
  ds_read_b128 v[76:79], v13 offset:0
  ds_read_b128 v[80:83], v14 offset:0
  ds_read_b128 v[84:87], v15 offset:0
  ds_read_b128 v[88:91], v16 offset:0
  ds_read_b128 v[92:95], v17 offset:0
  v_max3_f32 v26, v26, v176, v177
  v_max3_f32 v26, v26, v178, v179
  v_max3_f32 v26, v26, v180, v181
  v_max3_f32 v26, v26, v182, v183
  v_max3_f32 v27, v27, v184, v185
  v_max3_f32 v27, v27, v186, v187
  v_max3_f32 v27, v27, v188, v189
  v_max3_f32 v27, v27, v190, v191
  s_waitcnt lgkmcnt(7)
  v_mfma_f32_32x32x16_bf16 v[192:207], v[64:67], v[32:35], 0
  s_waitcnt lgkmcnt(6)
  v_mfma_f32_32x32x16_bf16 v[192:207], v[68:71], v[36:39], v[192:207]
  s_waitcnt lgkmcnt(5)
  v_mfma_f32_32x32x16_bf16 v[192:207], v[72:75], v[40:43], v[192:207]
  s_waitcnt lgkmcnt(4)
  v_mfma_f32_32x32x16_bf16 v[192:207], v[76:79], v[44:47], v[192:207]
  s_waitcnt lgkmcnt(3)
  v_mfma_f32_32x32x16_bf16 v[192:207], v[80:83], v[48:51], v[192:207]
  s_waitcnt lgkmcnt(2)
  v_mfma_f32_32x32x16_bf16 v[192:207], v[84:87], v[52:55], v[192:207]
  s_waitcnt lgkmcnt(1)
  v_mfma_f32_32x32x16_bf16 v[192:207], v[88:91], v[56:59], v[192:207]
  s_waitcnt lgkmcnt(0)
  v_mfma_f32_32x32x16_bf16 v[192:207], v[92:95], v[60:63], v[192:207]
  s_add_u32 s77, s82, 49152
  s_and_b32 s77, s77, 0xffff
  s_add_u32 s77, s77, s74
  s_add_u32 m0, s75, 0
  s_nop 0
  buffer_load_dwordx4 v6, s[52:55], s77 offen offset:0 lds
  buffer_load_dwordx4 v7, s[52:55], s77 offen offset:1024 lds
  buffer_load_dwordx4 v8, s[52:55], s77 offen offset:2048 lds
  buffer_load_dwordx4 v9, s[52:55], s77 offen offset:3072 lds
  s_add_u32 m0, s75, 4096
  s_add_u32 s77, s77, 4096
  buffer_load_dwordx4 v6, s[52:55], s77 offen offset:0 lds
  buffer_load_dwordx4 v7, s[52:55], s77 offen offset:1024 lds
  buffer_load_dwordx4 v8, s[52:55], s77 offen offset:2048 lds
  buffer_load_dwordx4 v9, s[52:55], s77 offen offset:3072 lds
  s_waitcnt vmcnt(8)
  s_barrier
  ds_read_b128 v[64:67], v10 offset:8192
  ds_read_b128 v[68:71], v11 offset:8192
  ds_read_b128 v[72:75], v12 offset:8192
  ds_read_b128 v[76:79], v13 offset:8192
  ds_read_b128 v[80:83], v14 offset:8192
  ds_read_b128 v[84:87], v15 offset:8192
  ds_read_b128 v[88:91], v16 offset:8192
  ds_read_b128 v[92:95], v17 offset:8192
  v_max3_f32 v26, v26, v192, v193
  v_max3_f32 v26, v26, v194, v195
  v_max3_f32 v26, v26, v196, v197
  v_max3_f32 v26, v26, v198, v199
  v_max3_f32 v27, v27, v200, v201
  v_max3_f32 v27, v27, v202, v203
  v_max3_f32 v27, v27, v204, v205
  v_max3_f32 v27, v27, v206, v207
  s_waitcnt lgkmcnt(7)
  v_mfma_f32_32x32x16_bf16 v[208:223], v[64:67], v[32:35], 0
  s_waitcnt lgkmcnt(6)
  v_mfma_f32_32x32x16_bf16 v[208:223], v[68:71], v[36:39], v[208:223]
  s_waitcnt lgkmcnt(5)
  v_mfma_f32_32x32x16_bf16 v[208:223], v[72:75], v[40:43], v[208:223]
  s_waitcnt lgkmcnt(4)
  v_mfma_f32_32x32x16_bf16 v[208:223], v[76:79], v[44:47], v[208:223]
  s_waitcnt lgkmcnt(3)
  v_mfma_f32_32x32x16_bf16 v[208:223], v[80:83], v[48:51], v[208:223]
  s_waitcnt lgkmcnt(2)
  v_mfma_f32_32x32x16_bf16 v[208:223], v[84:87], v[52:55], v[208:223]
  s_waitcnt lgkmcnt(1)
  v_mfma_f32_32x32x16_bf16 v[208:223], v[88:91], v[56:59], v[208:223]
  s_waitcnt lgkmcnt(0)
  v_mfma_f32_32x32x16_bf16 v[208:223], v[92:95], v[60:63], v[208:223]
  s_add_u32 s77, s82, 57344
  s_and_b32 s77, s77, 0xffff
  s_add_u32 s77, s77, s74
  s_add_u32 m0, s75, 8192
  s_nop 0
  buffer_load_dwordx4 v6, s[52:55], s77 offen offset:0 lds
  buffer_load_dwordx4 v7, s[52:55], s77 offen offset:1024 lds
  buffer_load_dwordx4 v8, s[52:55], s77 offen offset:2048 lds
  buffer_load_dwordx4 v9, s[52:55], s77 offen offset:3072 lds
  s_add_u32 m0, s75, 12288
  s_add_u32 s77, s77, 4096
  buffer_load_dwordx4 v6, s[52:55], s77 offen offset:0 lds
  buffer_load_dwordx4 v7, s[52:55], s77 offen offset:1024 lds
  buffer_load_dwordx4 v8, s[52:55], s77 offen offset:2048 lds
  buffer_load_dwordx4 v9, s[52:55], s77 offen offset:3072 lds
  s_waitcnt vmcnt(8)
  s_barrier
  ds_read_b128 v[64:67], v10 offset:0
  ds_read_b128 v[68:71], v11 offset:0
  ds_read_b128 v[72:75], v12 offset:0
  ds_read_b128 v[76:79], v13 offset:0
  ds_read_b128 v[80:83], v14 offset:0
  ds_read_b128 v[84:87], v15 offset:0
  ds_read_b128 v[88:91], v16 offset:0
  ds_read_b128 v[92:95], v17 offset:0
  v_max3_f32 v26, v26, v208, v209
  v_max3_f32 v26, v26, v210, v211
  v_max3_f32 v26, v26, v212, v213
  v_max3_f32 v26, v26, v214, v215
  v_max3_f32 v27, v27, v216, v217
  v_max3_f32 v27, v27, v218, v219
  v_max3_f32 v27, v27, v220, v221
  v_max3_f32 v27, v27, v222, v223
  s_waitcnt lgkmcnt(7)
  v_mfma_f32_32x32x16_bf16 v[224:239], v[64:67], v[32:35], 0
  s_waitcnt lgkmcnt(6)
  v_mfma_f32_32x32x16_bf16 v[224:239], v[68:71], v[36:39], v[224:239]
  s_waitcnt lgkmcnt(5)
  v_mfma_f32_32x32x16_bf16 v[224:239], v[72:75], v[40:43], v[224:239]
  s_waitcnt lgkmcnt(4)
  v_mfma_f32_32x32x16_bf16 v[224:239], v[76:79], v[44:47], v[224:239]
  s_waitcnt lgkmcnt(3)
  v_mfma_f32_32x32x16_bf16 v[224:239], v[80:83], v[48:51], v[224:239]
  s_waitcnt lgkmcnt(2)
  v_mfma_f32_32x32x16_bf16 v[224:239], v[84:87], v[52:55], v[224:239]
  s_waitcnt lgkmcnt(1)
  v_mfma_f32_32x32x16_bf16 v[224:239], v[88:91], v[56:59], v[224:239]
  s_waitcnt lgkmcnt(0)
  v_mfma_f32_32x32x16_bf16 v[224:239], v[92:95], v[60:63], v[224:239]
  s_add_u32 s77, s82, 0
  s_and_b32 s77, s77, 0xffff
  s_add_u32 s77, s77, s74
  s_add_u32 m0, s75, 0
  s_nop 0
  buffer_load_dwordx4 v6, s[56:59], s77 offen offset:0 lds
  buffer_load_dwordx4 v7, s[56:59], s77 offen offset:1024 lds
  buffer_load_dwordx4 v8, s[56:59], s77 offen offset:2048 lds
  buffer_load_dwordx4 v9, s[56:59], s77 offen offset:3072 lds
  s_add_u32 m0, s75, 4096
  s_add_u32 s77, s77, 4096
  buffer_load_dwordx4 v6, s[56:59], s77 offen offset:0 lds
  buffer_load_dwordx4 v7, s[56:59], s77 offen offset:1024 lds
  buffer_load_dwordx4 v8, s[56:59], s77 offen offset:2048 lds
  buffer_load_dwordx4 v9, s[56:59], s77 offen offset:3072 lds
  s_waitcnt vmcnt(8)
  ds_read_b128 v[64:67], v10 offset:8192
  ds_read_b128 v[68:71], v11 offset:8192
  ds_read_b128 v[72:75], v12 offset:8192
  ds_read_b128 v[76:79], v13 offset:8192
  ds_read_b128 v[80:83], v14 offset:8192
  ds_read_b128 v[84:87], v15 offset:8192
  ds_read_b128 v[88:91], v16 offset:8192
  ds_read_b128 v[92:95], v17 offset:8192
  v_max3_f32 v26, v26, v224, v225
  v_max3_f32 v26, v26, v226, v227
  v_max3_f32 v26, v26, v228, v229
  v_max3_f32 v26, v26, v230, v231
  v_max3_f32 v27, v27, v232, v233
  v_max3_f32 v27, v27, v234, v235
  v_max3_f32 v27, v27, v236, v237
  v_max3_f32 v27, v27, v238, v239
  s_waitcnt lgkmcnt(7)
  v_mfma_f32_32x32x16_bf16 v[240:255], v[64:67], v[32:35], 0
  s_waitcnt lgkmcnt(6)
  v_mfma_f32_32x32x16_bf16 v[240:255], v[68:71], v[36:39], v[240:255]
  s_waitcnt lgkmcnt(5)
  v_mfma_f32_32x32x16_bf16 v[240:255], v[72:75], v[40:43], v[240:255]
  s_waitcnt lgkmcnt(4)
  v_mfma_f32_32x32x16_bf16 v[240:255], v[76:79], v[44:47], v[240:255]
  s_waitcnt lgkmcnt(3)
  v_mfma_f32_32x32x16_bf16 v[240:255], v[80:83], v[48:51], v[240:255]
  s_waitcnt lgkmcnt(2)
  v_mfma_f32_32x32x16_bf16 v[240:255], v[84:87], v[52:55], v[240:255]
  s_waitcnt lgkmcnt(1)
  v_mfma_f32_32x32x16_bf16 v[240:255], v[88:91], v[56:59], v[240:255]
  s_waitcnt lgkmcnt(0)
  v_mfma_f32_32x32x16_bf16 v[240:255], v[92:95], v[60:63], v[240:255]
  s_add_u32 s77, s82, 8192
  s_and_b32 s77, s77, 0xffff
  s_add_u32 s77, s77, s74
  s_add_u32 m0, s75, 8192
  s_nop 0
  buffer_load_dwordx4 v6, s[56:59], s77 offen offset:0 lds
  buffer_load_dwordx4 v7, s[56:59], s77 offen offset:1024 lds
  buffer_load_dwordx4 v8, s[56:59], s77 offen offset:2048 lds
  buffer_load_dwordx4 v9, s[56:59], s77 offen offset:3072 lds
  s_add_u32 m0, s75, 12288
  s_add_u32 s77, s77, 4096
  buffer_load_dwordx4 v6, s[56:59], s77 offen offset:0 lds
  buffer_load_dwordx4 v7, s[56:59], s77 offen offset:1024 lds
  buffer_load_dwordx4 v8, s[56:59], s77 offen offset:2048 lds
  buffer_load_dwordx4 v9, s[56:59], s77 offen offset:3072 lds
  s_nop 7
  v_max3_f32 v26, v26, v240, v241
  v_max3_f32 v26, v26, v242, v243
  v_max3_f32 v26, v26, v244, v245
  v_max3_f32 v26, v26, v246, v247
  v_max3_f32 v27, v27, v248, v249
  v_max3_f32 v27, v27, v250, v251
  v_max3_f32 v27, v27, v252, v253
  v_max3_f32 v27, v27, v254, v255
  v_max_f32 v26, v26, v27
  v_mov_b32 v27, v26
  s_nop 1
  v_permlane32_swap_b32 v26, v27
  s_nop 1
  v_max_f32 v32, v26, v27
  v_mul_f32 v33, s76, v32
  v_mov_b32 v34, 0
  v_mov_b32 v35, 0
  v_mov_b32 v36, 0
  v_mov_b32 v37, 0
  v_fma_f32 v40, v128, s76, -v33
  v_fma_f32 v41, v129, s76, -v33
  v_fma_f32 v42, v130, s76, -v33
  v_fma_f32 v43, v131, s76, -v33
  v_fma_f32 v44, v132, s76, -v33
  v_fma_f32 v45, v133, s76, -v33
  v_fma_f32 v46, v134, s76, -v33
  v_fma_f32 v47, v135, s76, -v33
  v_exp_f32 v40, v40
  v_exp_f32 v41, v41
  v_exp_f32 v42, v42
  v_exp_f32 v43, v43
  v_exp_f32 v44, v44
  v_exp_f32 v45, v45
  v_exp_f32 v46, v46
  v_exp_f32 v47, v47
  s_nop 0
  v_add_f32 v34, v34, v40
  v_add_f32 v35, v35, v41
  v_add_f32 v36, v36, v42
  v_add_f32 v37, v37, v43
  v_add_f32 v34, v34, v44
  v_add_f32 v35, v35, v45
  v_add_f32 v36, v36, v46
  v_add_f32 v37, v37, v47
  v_cvt_pk_bf16_f32 v48, v40, v41
  v_cvt_pk_bf16_f32 v49, v42, v43
  v_cvt_pk_bf16_f32 v50, v44, v45
  v_cvt_pk_bf16_f32 v51, v46, v47
  v_fma_f32 v40, v136, s76, -v33
  v_fma_f32 v41, v137, s76, -v33
  v_fma_f32 v42, v138, s76, -v33
  v_fma_f32 v43, v139, s76, -v33
  v_fma_f32 v44, v140, s76, -v33
  v_fma_f32 v45, v141, s76, -v33
  v_fma_f32 v46, v142, s76, -v33
  v_fma_f32 v47, v143, s76, -v33
  v_exp_f32 v40, v40
  v_exp_f32 v41, v41
  v_exp_f32 v42, v42
  v_exp_f32 v43, v43
  v_exp_f32 v44, v44
  v_exp_f32 v45, v45
  v_exp_f32 v46, v46
  v_exp_f32 v47, v47
  s_nop 0
  v_add_f32 v34, v34, v40
  v_add_f32 v35, v35, v41
  v_add_f32 v36, v36, v42
  v_add_f32 v37, v37, v43
  v_add_f32 v34, v34, v44
  v_add_f32 v35, v35, v45
  v_add_f32 v36, v36, v46
  v_add_f32 v37, v37, v47
  v_cvt_pk_bf16_f32 v52, v40, v41
  v_cvt_pk_bf16_f32 v53, v42, v43
  v_cvt_pk_bf16_f32 v54, v44, v45
  v_cvt_pk_bf16_f32 v55, v46, v47
  v_fma_f32 v40, v144, s76, -v33
  v_fma_f32 v41, v145, s76, -v33
  v_fma_f32 v42, v146, s76, -v33
  v_fma_f32 v43, v147, s76, -v33
  v_fma_f32 v44, v148, s76, -v33
  v_fma_f32 v45, v149, s76, -v33
  v_fma_f32 v46, v150, s76, -v33
  v_fma_f32 v47, v151, s76, -v33
  v_exp_f32 v40, v40
  v_exp_f32 v41, v41
  v_exp_f32 v42, v42
  v_exp_f32 v43, v43
  v_exp_f32 v44, v44
  v_exp_f32 v45, v45
  v_exp_f32 v46, v46
  v_exp_f32 v47, v47
  s_nop 0
  v_add_f32 v34, v34, v40
  v_add_f32 v35, v35, v41
  v_add_f32 v36, v36, v42
  v_add_f32 v37, v37, v43
  v_add_f32 v34, v34, v44
  v_add_f32 v35, v35, v45
  v_add_f32 v36, v36, v46
  v_add_f32 v37, v37, v47
  v_cvt_pk_bf16_f32 v56, v40, v41
  v_cvt_pk_bf16_f32 v57, v42, v43
  v_cvt_pk_bf16_f32 v58, v44, v45
  v_cvt_pk_bf16_f32 v59, v46, v47
  v_fma_f32 v40, v152, s76, -v33
  v_fma_f32 v41, v153, s76, -v33
  v_fma_f32 v42, v154, s76, -v33
  v_fma_f32 v43, v155, s76, -v33
  v_fma_f32 v44, v156, s76, -v33
  v_fma_f32 v45, v157, s76, -v33
  v_fma_f32 v46, v158, s76, -v33
  v_fma_f32 v47, v159, s76, -v33
  v_exp_f32 v40, v40
  v_exp_f32 v41, v41
  v_exp_f32 v42, v42
  v_exp_f32 v43, v43
  v_exp_f32 v44, v44
  v_exp_f32 v45, v45
  v_exp_f32 v46, v46
  v_exp_f32 v47, v47
  s_nop 0
  v_add_f32 v34, v34, v40
  v_add_f32 v35, v35, v41
  v_add_f32 v36, v36, v42
  v_add_f32 v37, v37, v43
  v_add_f32 v34, v34, v44
  v_add_f32 v35, v35, v45
  v_add_f32 v36, v36, v46
  v_add_f32 v37, v37, v47
  v_cvt_pk_bf16_f32 v60, v40, v41
  v_cvt_pk_bf16_f32 v61, v42, v43
  v_cvt_pk_bf16_f32 v62, v44, v45
  v_cvt_pk_bf16_f32 v63, v46, v47
  s_waitcnt vmcnt(8)
  s_barrier
  ds_read_b64_tr_b16 v[64:65], v18 offset:0
  ds_read_b64_tr_b16 v[66:67], v19 offset:0
  ds_read_b64_tr_b16 v[68:69], v20 offset:0
  ds_read_b64_tr_b16 v[70:71], v21 offset:0
  ds_read_b64_tr_b16 v[72:73], v22 offset:0
  ds_read_b64_tr_b16 v[74:75], v23 offset:0
  ds_read_b64_tr_b16 v[76:77], v24 offset:0
  ds_read_b64_tr_b16 v[78:79], v25 offset:0
  ds_read_b64_tr_b16 v[80:81], v18 offset:4096
  ds_read_b64_tr_b16 v[82:83], v19 offset:4096
  ds_read_b64_tr_b16 v[84:85], v20 offset:4096
  ds_read_b64_tr_b16 v[86:87], v21 offset:4096
  ds_read_b64_tr_b16 v[88:89], v22 offset:4096
  ds_read_b64_tr_b16 v[90:91], v23 offset:4096
  ds_read_b64_tr_b16 v[92:93], v24 offset:4096
  ds_read_b64_tr_b16 v[94:95], v25 offset:4096
  s_waitcnt lgkmcnt(14)
  v_mfma_f32_32x32x16_bf16 v[128:143], v[64:67], v[48:51], 0
  s_waitcnt lgkmcnt(12)
  v_mfma_f32_32x32x16_bf16 v[144:159], v[68:71], v[48:51], 0
  s_waitcnt lgkmcnt(10)
  v_mfma_f32_32x32x16_bf16 v[96:111], v[72:75], v[48:51], 0
  s_waitcnt lgkmcnt(8)
  v_mfma_f32_32x32x16_bf16 v[112:127], v[76:79], v[48:51], 0
  s_waitcnt lgkmcnt(6)
  v_mfma_f32_32x32x16_bf16 v[128:143], v[80:83], v[52:55], v[128:143]
  s_waitcnt lgkmcnt(4)
  v_mfma_f32_32x32x16_bf16 v[144:159], v[84:87], v[52:55], v[144:159]
  s_waitcnt lgkmcnt(2)
  v_mfma_f32_32x32x16_bf16 v[96:111], v[88:91], v[52:55], v[96:111]
  s_waitcnt lgkmcnt(0)
  v_mfma_f32_32x32x16_bf16 v[112:127], v[92:95], v[52:55], v[112:127]
  s_add_u32 s77, s82, 16384
  s_and_b32 s77, s77, 0xffff
  s_add_u32 s77, s77, s74
  s_add_u32 m0, s75, 0
  s_nop 0
  buffer_load_dwordx4 v6, s[56:59], s77 offen offset:0 lds
  buffer_load_dwordx4 v7, s[56:59], s77 offen offset:1024 lds
  buffer_load_dwordx4 v8, s[56:59], s77 offen offset:2048 lds
  buffer_load_dwordx4 v9, s[56:59], s77 offen offset:3072 lds
  s_add_u32 m0, s75, 4096
  s_add_u32 s77, s77, 4096
  buffer_load_dwordx4 v6, s[56:59], s77 offen offset:0 lds
  buffer_load_dwordx4 v7, s[56:59], s77 offen offset:1024 lds
  buffer_load_dwordx4 v8, s[56:59], s77 offen offset:2048 lds
  buffer_load_dwordx4 v9, s[56:59], s77 offen offset:3072 lds
  v_fma_f32 v40, v160, s76, -v33
  v_fma_f32 v41, v161, s76, -v33
  v_fma_f32 v42, v162, s76, -v33
  v_fma_f32 v43, v163, s76, -v33
  v_fma_f32 v44, v164, s76, -v33
  v_fma_f32 v45, v165, s76, -v33
  v_fma_f32 v46, v166, s76, -v33
  v_fma_f32 v47, v167, s76, -v33
  v_exp_f32 v40, v40
  v_exp_f32 v41, v41
  v_exp_f32 v42, v42
  v_exp_f32 v43, v43
  v_exp_f32 v44, v44
  v_exp_f32 v45, v45
  v_exp_f32 v46, v46
  v_exp_f32 v47, v47
  s_nop 0
  v_add_f32 v34, v34, v40
  v_add_f32 v35, v35, v41
  v_add_f32 v36, v36, v42
  v_add_f32 v37, v37, v43
  v_add_f32 v34, v34, v44
  v_add_f32 v35, v35, v45
  v_add_f32 v36, v36, v46
  v_add_f32 v37, v37, v47
  v_cvt_pk_bf16_f32 v48, v40, v41
  v_cvt_pk_bf16_f32 v49, v42, v43
  v_cvt_pk_bf16_f32 v50, v44, v45
  v_cvt_pk_bf16_f32 v51, v46, v47
  v_fma_f32 v40, v168, s76, -v33
  v_fma_f32 v41, v169, s76, -v33
  v_fma_f32 v42, v170, s76, -v33
  v_fma_f32 v43, v171, s76, -v33
  v_fma_f32 v44, v172, s76, -v33
  v_fma_f32 v45, v173, s76, -v33
  v_fma_f32 v46, v174, s76, -v33
  v_fma_f32 v47, v175, s76, -v33
  v_exp_f32 v40, v40
  v_exp_f32 v41, v41
  v_exp_f32 v42, v42
  v_exp_f32 v43, v43
  v_exp_f32 v44, v44
  v_exp_f32 v45, v45
  v_exp_f32 v46, v46
  v_exp_f32 v47, v47
  s_nop 0
  v_add_f32 v34, v34, v40
  v_add_f32 v35, v35, v41
  v_add_f32 v36, v36, v42
  v_add_f32 v37, v37, v43
  v_add_f32 v34, v34, v44
  v_add_f32 v35, v35, v45
  v_add_f32 v36, v36, v46
  v_add_f32 v37, v37, v47
  v_cvt_pk_bf16_f32 v52, v40, v41
  v_cvt_pk_bf16_f32 v53, v42, v43
  v_cvt_pk_bf16_f32 v54, v44, v45
  v_cvt_pk_bf16_f32 v55, v46, v47
  s_waitcnt vmcnt(8)
  s_barrier
  ds_read_b64_tr_b16 v[64:65], v18 offset:8192
  ds_read_b64_tr_b16 v[66:67], v19 offset:8192
  ds_read_b64_tr_b16 v[68:69], v20 offset:8192
  ds_read_b64_tr_b16 v[70:71], v21 offset:8192
  ds_read_b64_tr_b16 v[72:73], v22 offset:8192
  ds_read_b64_tr_b16 v[74:75], v23 offset:8192
  ds_read_b64_tr_b16 v[76:77], v24 offset:8192
  ds_read_b64_tr_b16 v[78:79], v25 offset:8192
  ds_read_b64_tr_b16 v[80:81], v18 offset:12288
  ds_read_b64_tr_b16 v[82:83], v19 offset:12288
  ds_read_b64_tr_b16 v[84:85], v20 offset:12288
  ds_read_b64_tr_b16 v[86:87], v21 offset:12288
  ds_read_b64_tr_b16 v[88:89], v22 offset:12288
  ds_read_b64_tr_b16 v[90:91], v23 offset:12288
  ds_read_b64_tr_b16 v[92:93], v24 offset:12288
  ds_read_b64_tr_b16 v[94:95], v25 offset:12288
  s_waitcnt lgkmcnt(14)
  v_mfma_f32_32x32x16_bf16 v[128:143], v[64:67], v[56:59], v[128:143]
  s_waitcnt lgkmcnt(12)
  v_mfma_f32_32x32x16_bf16 v[144:159], v[68:71], v[56:59], v[144:159]
  s_waitcnt lgkmcnt(10)
  v_mfma_f32_32x32x16_bf16 v[96:111], v[72:75], v[56:59], v[96:111]
  s_waitcnt lgkmcnt(8)
  v_mfma_f32_32x32x16_bf16 v[112:127], v[76:79], v[56:59], v[112:127]
  s_waitcnt lgkmcnt(6)
  v_mfma_f32_32x32x16_bf16 v[128:143], v[80:83], v[60:63], v[128:143]
  s_waitcnt lgkmcnt(4)
  v_mfma_f32_32x32x16_bf16 v[144:159], v[84:87], v[60:63], v[144:159]
  s_waitcnt lgkmcnt(2)
  v_mfma_f32_32x32x16_bf16 v[96:111], v[88:91], v[60:63], v[96:111]
  s_waitcnt lgkmcnt(0)
  v_mfma_f32_32x32x16_bf16 v[112:127], v[92:95], v[60:63], v[112:127]
  s_add_u32 s77, s82, 24576
  s_and_b32 s77, s77, 0xffff
  s_add_u32 s77, s77, s74
  s_add_u32 m0, s75, 8192
  s_nop 0
  buffer_load_dwordx4 v6, s[56:59], s77 offen offset:0 lds
  buffer_load_dwordx4 v7, s[56:59], s77 offen offset:1024 lds
  buffer_load_dwordx4 v8, s[56:59], s77 offen offset:2048 lds
  buffer_load_dwordx4 v9, s[56:59], s77 offen offset:3072 lds
  s_add_u32 m0, s75, 12288
  s_add_u32 s77, s77, 4096
  buffer_load_dwordx4 v6, s[56:59], s77 offen offset:0 lds
  buffer_load_dwordx4 v7, s[56:59], s77 offen offset:1024 lds
  buffer_load_dwordx4 v8, s[56:59], s77 offen offset:2048 lds
  buffer_load_dwordx4 v9, s[56:59], s77 offen offset:3072 lds
  v_fma_f32 v40, v176, s76, -v33
  v_fma_f32 v41, v177, s76, -v33
  v_fma_f32 v42, v178, s76, -v33
  v_fma_f32 v43, v179, s76, -v33
  v_fma_f32 v44, v180, s76, -v33
  v_fma_f32 v45, v181, s76, -v33
  v_fma_f32 v46, v182, s76, -v33
  v_fma_f32 v47, v183, s76, -v33
  v_exp_f32 v40, v40
  v_exp_f32 v41, v41
  v_exp_f32 v42, v42
  v_exp_f32 v43, v43
  v_exp_f32 v44, v44
  v_exp_f32 v45, v45
  v_exp_f32 v46, v46
  v_exp_f32 v47, v47
  s_nop 0
  v_add_f32 v34, v34, v40
  v_add_f32 v35, v35, v41
  v_add_f32 v36, v36, v42
  v_add_f32 v37, v37, v43
  v_add_f32 v34, v34, v44
  v_add_f32 v35, v35, v45
  v_add_f32 v36, v36, v46
  v_add_f32 v37, v37, v47
  v_cvt_pk_bf16_f32 v56, v40, v41
  v_cvt_pk_bf16_f32 v57, v42, v43
  v_cvt_pk_bf16_f32 v58, v44, v45
  v_cvt_pk_bf16_f32 v59, v46, v47
  v_fma_f32 v40, v184, s76, -v33
  v_fma_f32 v41, v185, s76, -v33
  v_fma_f32 v42, v186, s76, -v33
  v_fma_f32 v43, v187, s76, -v33
  v_fma_f32 v44, v188, s76, -v33
  v_fma_f32 v45, v189, s76, -v33
  v_fma_f32 v46, v190, s76, -v33
  v_fma_f32 v47, v191, s76, -v33
  v_exp_f32 v40, v40
  v_exp_f32 v41, v41
  v_exp_f32 v42, v42
  v_exp_f32 v43, v43
  v_exp_f32 v44, v44
  v_exp_f32 v45, v45
  v_exp_f32 v46, v46
  v_exp_f32 v47, v47
  s_nop 0
  v_add_f32 v34, v34, v40
  v_add_f32 v35, v35, v41
  v_add_f32 v36, v36, v42
  v_add_f32 v37, v37, v43
  v_add_f32 v34, v34, v44
  v_add_f32 v35, v35, v45
  v_add_f32 v36, v36, v46
  v_add_f32 v37, v37, v47
  v_cvt_pk_bf16_f32 v60, v40, v41
  v_cvt_pk_bf16_f32 v61, v42, v43
  v_cvt_pk_bf16_f32 v62, v44, v45
  v_cvt_pk_bf16_f32 v63, v46, v47
  s_waitcnt vmcnt(8)
  ds_read_b64_tr_b16 v[64:65], v18 offset:0
  ds_read_b64_tr_b16 v[66:67], v19 offset:0
  ds_read_b64_tr_b16 v[68:69], v20 offset:0
  ds_read_b64_tr_b16 v[70:71], v21 offset:0
  ds_read_b64_tr_b16 v[72:73], v22 offset:0
  ds_read_b64_tr_b16 v[74:75], v23 offset:0
  ds_read_b64_tr_b16 v[76:77], v24 offset:0
  ds_read_b64_tr_b16 v[78:79], v25 offset:0
  ds_read_b64_tr_b16 v[80:81], v18 offset:4096
  ds_read_b64_tr_b16 v[82:83], v19 offset:4096
  ds_read_b64_tr_b16 v[84:85], v20 offset:4096
  ds_read_b64_tr_b16 v[86:87], v21 offset:4096
  ds_read_b64_tr_b16 v[88:89], v22 offset:4096
  ds_read_b64_tr_b16 v[90:91], v23 offset:4096
  ds_read_b64_tr_b16 v[92:93], v24 offset:4096
  ds_read_b64_tr_b16 v[94:95], v25 offset:4096
  s_waitcnt lgkmcnt(14)
  v_mfma_f32_32x32x16_bf16 v[128:143], v[64:67], v[48:51], v[128:143]
  s_waitcnt lgkmcnt(12)
  v_mfma_f32_32x32x16_bf16 v[144:159], v[68:71], v[48:51], v[144:159]
  s_waitcnt lgkmcnt(10)
  v_mfma_f32_32x32x16_bf16 v[96:111], v[72:75], v[48:51], v[96:111]
  s_waitcnt lgkmcnt(8)
  v_mfma_f32_32x32x16_bf16 v[112:127], v[76:79], v[48:51], v[112:127]
  s_waitcnt lgkmcnt(6)
  v_mfma_f32_32x32x16_bf16 v[128:143], v[80:83], v[52:55], v[128:143]
  s_waitcnt lgkmcnt(4)
  v_mfma_f32_32x32x16_bf16 v[144:159], v[84:87], v[52:55], v[144:159]
  s_waitcnt lgkmcnt(2)
  v_mfma_f32_32x32x16_bf16 v[96:111], v[88:91], v[52:55], v[96:111]
  s_waitcnt lgkmcnt(0)
  v_mfma_f32_32x32x16_bf16 v[112:127], v[92:95], v[52:55], v[112:127]
  s_add_u32 s77, s82, 32768
  s_and_b32 s77, s77, 0xffff
  s_add_u32 s77, s77, s74
  s_add_u32 m0, s75, 0
  s_nop 0
  buffer_load_dwordx4 v6, s[56:59], s77 offen offset:0 lds
  buffer_load_dwordx4 v7, s[56:59], s77 offen offset:1024 lds
  buffer_load_dwordx4 v8, s[56:59], s77 offen offset:2048 lds
  buffer_load_dwordx4 v9, s[56:59], s77 offen offset:3072 lds
  s_add_u32 m0, s75, 4096
  s_add_u32 s77, s77, 4096
  buffer_load_dwordx4 v6, s[56:59], s77 offen offset:0 lds
  buffer_load_dwordx4 v7, s[56:59], s77 offen offset:1024 lds
  buffer_load_dwordx4 v8, s[56:59], s77 offen offset:2048 lds
  buffer_load_dwordx4 v9, s[56:59], s77 offen offset:3072 lds
  v_fma_f32 v40, v192, s76, -v33
  v_fma_f32 v41, v193, s76, -v33
  v_fma_f32 v42, v194, s76, -v33
  v_fma_f32 v43, v195, s76, -v33
  v_fma_f32 v44, v196, s76, -v33
  v_fma_f32 v45, v197, s76, -v33
  v_fma_f32 v46, v198, s76, -v33
  v_fma_f32 v47, v199, s76, -v33
  v_exp_f32 v40, v40
  v_exp_f32 v41, v41
  v_exp_f32 v42, v42
  v_exp_f32 v43, v43
  v_exp_f32 v44, v44
  v_exp_f32 v45, v45
  v_exp_f32 v46, v46
  v_exp_f32 v47, v47
  s_nop 0
  v_add_f32 v34, v34, v40
  v_add_f32 v35, v35, v41
  v_add_f32 v36, v36, v42
  v_add_f32 v37, v37, v43
  v_add_f32 v34, v34, v44
  v_add_f32 v35, v35, v45
  v_add_f32 v36, v36, v46
  v_add_f32 v37, v37, v47
  v_cvt_pk_bf16_f32 v48, v40, v41
  v_cvt_pk_bf16_f32 v49, v42, v43
  v_cvt_pk_bf16_f32 v50, v44, v45
  v_cvt_pk_bf16_f32 v51, v46, v47
  v_fma_f32 v40, v200, s76, -v33
  v_fma_f32 v41, v201, s76, -v33
  v_fma_f32 v42, v202, s76, -v33
  v_fma_f32 v43, v203, s76, -v33
  v_fma_f32 v44, v204, s76, -v33
  v_fma_f32 v45, v205, s76, -v33
  v_fma_f32 v46, v206, s76, -v33
  v_fma_f32 v47, v207, s76, -v33
  v_exp_f32 v40, v40
  v_exp_f32 v41, v41
  v_exp_f32 v42, v42
  v_exp_f32 v43, v43
  v_exp_f32 v44, v44
  v_exp_f32 v45, v45
  v_exp_f32 v46, v46
  v_exp_f32 v47, v47
  s_nop 0
  v_add_f32 v34, v34, v40
  v_add_f32 v35, v35, v41
  v_add_f32 v36, v36, v42
  v_add_f32 v37, v37, v43
  v_add_f32 v34, v34, v44
  v_add_f32 v35, v35, v45
  v_add_f32 v36, v36, v46
  v_add_f32 v37, v37, v47
  v_cvt_pk_bf16_f32 v52, v40, v41
  v_cvt_pk_bf16_f32 v53, v42, v43
  v_cvt_pk_bf16_f32 v54, v44, v45
  v_cvt_pk_bf16_f32 v55, v46, v47
  s_waitcnt vmcnt(8)
  s_barrier
  ds_read_b64_tr_b16 v[64:65], v18 offset:8192
  ds_read_b64_tr_b16 v[66:67], v19 offset:8192
  ds_read_b64_tr_b16 v[68:69], v20 offset:8192
  ds_read_b64_tr_b16 v[70:71], v21 offset:8192
  ds_read_b64_tr_b16 v[72:73], v22 offset:8192
  ds_read_b64_tr_b16 v[74:75], v23 offset:8192
  ds_read_b64_tr_b16 v[76:77], v24 offset:8192
  ds_read_b64_tr_b16 v[78:79], v25 offset:8192
  ds_read_b64_tr_b16 v[80:81], v18 offset:12288
  ds_read_b64_tr_b16 v[82:83], v19 offset:12288
  ds_read_b64_tr_b16 v[84:85], v20 offset:12288
  ds_read_b64_tr_b16 v[86:87], v21 offset:12288
  ds_read_b64_tr_b16 v[88:89], v22 offset:12288
  ds_read_b64_tr_b16 v[90:91], v23 offset:12288
  ds_read_b64_tr_b16 v[92:93], v24 offset:12288
  ds_read_b64_tr_b16 v[94:95], v25 offset:12288
  s_waitcnt lgkmcnt(14)
  v_mfma_f32_32x32x16_bf16 v[128:143], v[64:67], v[56:59], v[128:143]
  s_waitcnt lgkmcnt(12)
  v_mfma_f32_32x32x16_bf16 v[144:159], v[68:71], v[56:59], v[144:159]
  s_waitcnt lgkmcnt(10)
  v_mfma_f32_32x32x16_bf16 v[96:111], v[72:75], v[56:59], v[96:111]
  s_waitcnt lgkmcnt(8)
  v_mfma_f32_32x32x16_bf16 v[112:127], v[76:79], v[56:59], v[112:127]
  s_waitcnt lgkmcnt(6)
  v_mfma_f32_32x32x16_bf16 v[128:143], v[80:83], v[60:63], v[128:143]
  s_waitcnt lgkmcnt(4)
  v_mfma_f32_32x32x16_bf16 v[144:159], v[84:87], v[60:63], v[144:159]
  s_waitcnt lgkmcnt(2)
  v_mfma_f32_32x32x16_bf16 v[96:111], v[88:91], v[60:63], v[96:111]
  s_waitcnt lgkmcnt(0)
  v_mfma_f32_32x32x16_bf16 v[112:127], v[92:95], v[60:63], v[112:127]
  s_add_u32 s77, s82, 40960
  s_and_b32 s77, s77, 0xffff
  s_add_u32 s77, s77, s74
  s_add_u32 m0, s75, 8192
  s_nop 0
  buffer_load_dwordx4 v6, s[56:59], s77 offen offset:0 lds
  buffer_load_dwordx4 v7, s[56:59], s77 offen offset:1024 lds
  buffer_load_dwordx4 v8, s[56:59], s77 offen offset:2048 lds
  buffer_load_dwordx4 v9, s[56:59], s77 offen offset:3072 lds
  s_add_u32 m0, s75, 12288
  s_add_u32 s77, s77, 4096
  buffer_load_dwordx4 v6, s[56:59], s77 offen offset:0 lds
  buffer_load_dwordx4 v7, s[56:59], s77 offen offset:1024 lds
  buffer_load_dwordx4 v8, s[56:59], s77 offen offset:2048 lds
  buffer_load_dwordx4 v9, s[56:59], s77 offen offset:3072 lds
  v_fma_f32 v40, v208, s76, -v33
  v_fma_f32 v41, v209, s76, -v33
  v_fma_f32 v42, v210, s76, -v33
  v_fma_f32 v43, v211, s76, -v33
  v_fma_f32 v44, v212, s76, -v33
  v_fma_f32 v45, v213, s76, -v33
  v_fma_f32 v46, v214, s76, -v33
  v_fma_f32 v47, v215, s76, -v33
  v_exp_f32 v40, v40
  v_exp_f32 v41, v41
  v_exp_f32 v42, v42
  v_exp_f32 v43, v43
  v_exp_f32 v44, v44
  v_exp_f32 v45, v45
  v_exp_f32 v46, v46
  v_exp_f32 v47, v47
  s_nop 0
  v_add_f32 v34, v34, v40
  v_add_f32 v35, v35, v41
  v_add_f32 v36, v36, v42
  v_add_f32 v37, v37, v43
  v_add_f32 v34, v34, v44
  v_add_f32 v35, v35, v45
  v_add_f32 v36, v36, v46
  v_add_f32 v37, v37, v47
  v_cvt_pk_bf16_f32 v56, v40, v41
  v_cvt_pk_bf16_f32 v57, v42, v43
  v_cvt_pk_bf16_f32 v58, v44, v45
  v_cvt_pk_bf16_f32 v59, v46, v47
  v_fma_f32 v40, v216, s76, -v33
  v_fma_f32 v41, v217, s76, -v33
  v_fma_f32 v42, v218, s76, -v33
  v_fma_f32 v43, v219, s76, -v33
  v_fma_f32 v44, v220, s76, -v33
  v_fma_f32 v45, v221, s76, -v33
  v_fma_f32 v46, v222, s76, -v33
  v_fma_f32 v47, v223, s76, -v33
  v_exp_f32 v40, v40
  v_exp_f32 v41, v41
  v_exp_f32 v42, v42
  v_exp_f32 v43, v43
  v_exp_f32 v44, v44
  v_exp_f32 v45, v45
  v_exp_f32 v46, v46
  v_exp_f32 v47, v47
  s_nop 0
  v_add_f32 v34, v34, v40
  v_add_f32 v35, v35, v41
  v_add_f32 v36, v36, v42
  v_add_f32 v37, v37, v43
  v_add_f32 v34, v34, v44
  v_add_f32 v35, v35, v45
  v_add_f32 v36, v36, v46
  v_add_f32 v37, v37, v47
  v_cvt_pk_bf16_f32 v60, v40, v41
  v_cvt_pk_bf16_f32 v61, v42, v43
  v_cvt_pk_bf16_f32 v62, v44, v45
  v_cvt_pk_bf16_f32 v63, v46, v47
  s_waitcnt vmcnt(8)
  s_barrier
  ds_read_b64_tr_b16 v[64:65], v18 offset:0
  ds_read_b64_tr_b16 v[66:67], v19 offset:0
  ds_read_b64_tr_b16 v[68:69], v20 offset:0
  ds_read_b64_tr_b16 v[70:71], v21 offset:0
  ds_read_b64_tr_b16 v[72:73], v22 offset:0
  ds_read_b64_tr_b16 v[74:75], v23 offset:0
  ds_read_b64_tr_b16 v[76:77], v24 offset:0
  ds_read_b64_tr_b16 v[78:79], v25 offset:0
  ds_read_b64_tr_b16 v[80:81], v18 offset:4096
  ds_read_b64_tr_b16 v[82:83], v19 offset:4096
  ds_read_b64_tr_b16 v[84:85], v20 offset:4096
  ds_read_b64_tr_b16 v[86:87], v21 offset:4096
  ds_read_b64_tr_b16 v[88:89], v22 offset:4096
  ds_read_b64_tr_b16 v[90:91], v23 offset:4096
  ds_read_b64_tr_b16 v[92:93], v24 offset:4096
  ds_read_b64_tr_b16 v[94:95], v25 offset:4096
  s_waitcnt lgkmcnt(14)
  v_mfma_f32_32x32x16_bf16 v[128:143], v[64:67], v[48:51], v[128:143]
  s_waitcnt lgkmcnt(12)
  v_mfma_f32_32x32x16_bf16 v[144:159], v[68:71], v[48:51], v[144:159]
  s_waitcnt lgkmcnt(10)
  v_mfma_f32_32x32x16_bf16 v[96:111], v[72:75], v[48:51], v[96:111]
  s_waitcnt lgkmcnt(8)
  v_mfma_f32_32x32x16_bf16 v[112:127], v[76:79], v[48:51], v[112:127]
  s_waitcnt lgkmcnt(6)
  v_mfma_f32_32x32x16_bf16 v[128:143], v[80:83], v[52:55], v[128:143]
  s_waitcnt lgkmcnt(4)
  v_mfma_f32_32x32x16_bf16 v[144:159], v[84:87], v[52:55], v[144:159]
  s_waitcnt lgkmcnt(2)
  v_mfma_f32_32x32x16_bf16 v[96:111], v[88:91], v[52:55], v[96:111]
  s_waitcnt lgkmcnt(0)
  v_mfma_f32_32x32x16_bf16 v[112:127], v[92:95], v[52:55], v[112:127]
  s_add_u32 s77, s82, 49152
  s_and_b32 s77, s77, 0xffff
  s_add_u32 s77, s77, s74
  s_add_u32 m0, s75, 0
  s_nop 0
  buffer_load_dwordx4 v6, s[56:59], s77 offen offset:0 lds
  buffer_load_dwordx4 v7, s[56:59], s77 offen offset:1024 lds
  buffer_load_dwordx4 v8, s[56:59], s77 offen offset:2048 lds
  buffer_load_dwordx4 v9, s[56:59], s77 offen offset:3072 lds
  s_add_u32 m0, s75, 4096
  s_add_u32 s77, s77, 4096
  buffer_load_dwordx4 v6, s[56:59], s77 offen offset:0 lds
  buffer_load_dwordx4 v7, s[56:59], s77 offen offset:1024 lds
  buffer_load_dwordx4 v8, s[56:59], s77 offen offset:2048 lds
  buffer_load_dwordx4 v9, s[56:59], s77 offen offset:3072 lds
  v_fma_f32 v40, v224, s76, -v33
  v_fma_f32 v41, v225, s76, -v33
  v_fma_f32 v42, v226, s76, -v33
  v_fma_f32 v43, v227, s76, -v33
  v_fma_f32 v44, v228, s76, -v33
  v_fma_f32 v45, v229, s76, -v33
  v_fma_f32 v46, v230, s76, -v33
  v_fma_f32 v47, v231, s76, -v33
  v_exp_f32 v40, v40
  v_exp_f32 v41, v41
  v_exp_f32 v42, v42
  v_exp_f32 v43, v43
  v_exp_f32 v44, v44
  v_exp_f32 v45, v45
  v_exp_f32 v46, v46
  v_exp_f32 v47, v47
  s_nop 0
  v_add_f32 v34, v34, v40
  v_add_f32 v35, v35, v41
  v_add_f32 v36, v36, v42
  v_add_f32 v37, v37, v43
  v_add_f32 v34, v34, v44
  v_add_f32 v35, v35, v45
  v_add_f32 v36, v36, v46
  v_add_f32 v37, v37, v47
  v_cvt_pk_bf16_f32 v48, v40, v41
  v_cvt_pk_bf16_f32 v49, v42, v43
  v_cvt_pk_bf16_f32 v50, v44, v45
  v_cvt_pk_bf16_f32 v51, v46, v47
  v_fma_f32 v40, v232, s76, -v33
  v_fma_f32 v41, v233, s76, -v33
  v_fma_f32 v42, v234, s76, -v33
  v_fma_f32 v43, v235, s76, -v33
  v_fma_f32 v44, v236, s76, -v33
  v_fma_f32 v45, v237, s76, -v33
  v_fma_f32 v46, v238, s76, -v33
  v_fma_f32 v47, v239, s76, -v33
  v_exp_f32 v40, v40
  v_exp_f32 v41, v41
  v_exp_f32 v42, v42
  v_exp_f32 v43, v43
  v_exp_f32 v44, v44
  v_exp_f32 v45, v45
  v_exp_f32 v46, v46
  v_exp_f32 v47, v47
  s_nop 0
  v_add_f32 v34, v34, v40
  v_add_f32 v35, v35, v41
  v_add_f32 v36, v36, v42
  v_add_f32 v37, v37, v43
  v_add_f32 v34, v34, v44
  v_add_f32 v35, v35, v45
  v_add_f32 v36, v36, v46
  v_add_f32 v37, v37, v47
  v_cvt_pk_bf16_f32 v52, v40, v41
  v_cvt_pk_bf16_f32 v53, v42, v43
  v_cvt_pk_bf16_f32 v54, v44, v45
  v_cvt_pk_bf16_f32 v55, v46, v47
  s_waitcnt vmcnt(8)
  ds_read_b64_tr_b16 v[64:65], v18 offset:8192
  ds_read_b64_tr_b16 v[66:67], v19 offset:8192
  ds_read_b64_tr_b16 v[68:69], v20 offset:8192
  ds_read_b64_tr_b16 v[70:71], v21 offset:8192
  ds_read_b64_tr_b16 v[72:73], v22 offset:8192
  ds_read_b64_tr_b16 v[74:75], v23 offset:8192
  ds_read_b64_tr_b16 v[76:77], v24 offset:8192
  ds_read_b64_tr_b16 v[78:79], v25 offset:8192
  ds_read_b64_tr_b16 v[80:81], v18 offset:12288
  ds_read_b64_tr_b16 v[82:83], v19 offset:12288
  ds_read_b64_tr_b16 v[84:85], v20 offset:12288
  ds_read_b64_tr_b16 v[86:87], v21 offset:12288
  ds_read_b64_tr_b16 v[88:89], v22 offset:12288
  ds_read_b64_tr_b16 v[90:91], v23 offset:12288
  ds_read_b64_tr_b16 v[92:93], v24 offset:12288
  ds_read_b64_tr_b16 v[94:95], v25 offset:12288
  s_waitcnt lgkmcnt(14)
  v_mfma_f32_32x32x16_bf16 v[128:143], v[64:67], v[56:59], v[128:143]
  s_waitcnt lgkmcnt(12)
  v_mfma_f32_32x32x16_bf16 v[144:159], v[68:71], v[56:59], v[144:159]
  s_waitcnt lgkmcnt(10)
  v_mfma_f32_32x32x16_bf16 v[96:111], v[72:75], v[56:59], v[96:111]
  s_waitcnt lgkmcnt(8)
  v_mfma_f32_32x32x16_bf16 v[112:127], v[76:79], v[56:59], v[112:127]
  s_waitcnt lgkmcnt(6)
  v_mfma_f32_32x32x16_bf16 v[128:143], v[80:83], v[60:63], v[128:143]
  s_waitcnt lgkmcnt(4)
  v_mfma_f32_32x32x16_bf16 v[144:159], v[84:87], v[60:63], v[144:159]
  s_waitcnt lgkmcnt(2)
  v_mfma_f32_32x32x16_bf16 v[96:111], v[88:91], v[60:63], v[96:111]
  s_waitcnt lgkmcnt(0)
  v_mfma_f32_32x32x16_bf16 v[112:127], v[92:95], v[60:63], v[112:127]
  s_add_u32 s77, s82, 57344
  s_and_b32 s77, s77, 0xffff
  s_add_u32 s77, s77, s74
  s_add_u32 m0, s75, 8192
  s_nop 0
  buffer_load_dwordx4 v6, s[56:59], s77 offen offset:0 lds
  buffer_load_dwordx4 v7, s[56:59], s77 offen offset:1024 lds
  buffer_load_dwordx4 v8, s[56:59], s77 offen offset:2048 lds
  buffer_load_dwordx4 v9, s[56:59], s77 offen offset:3072 lds
  s_add_u32 m0, s75, 12288
  s_add_u32 s77, s77, 4096
  buffer_load_dwordx4 v6, s[56:59], s77 offen offset:0 lds
  buffer_load_dwordx4 v7, s[56:59], s77 offen offset:1024 lds
  buffer_load_dwordx4 v8, s[56:59], s77 offen offset:2048 lds
  buffer_load_dwordx4 v9, s[56:59], s77 offen offset:3072 lds
  v_fma_f32 v40, v240, s76, -v33
  v_fma_f32 v41, v241, s76, -v33
  v_fma_f32 v42, v242, s76, -v33
  v_fma_f32 v43, v243, s76, -v33
  v_fma_f32 v44, v244, s76, -v33
  v_fma_f32 v45, v245, s76, -v33
  v_fma_f32 v46, v246, s76, -v33
  v_fma_f32 v47, v247, s76, -v33
  v_exp_f32 v40, v40
  v_exp_f32 v41, v41
  v_exp_f32 v42, v42
  v_exp_f32 v43, v43
  v_exp_f32 v44, v44
  v_exp_f32 v45, v45
  v_exp_f32 v46, v46
  v_exp_f32 v47, v47
  s_nop 0
  v_add_f32 v34, v34, v40
  v_add_f32 v35, v35, v41
  v_add_f32 v36, v36, v42
  v_add_f32 v37, v37, v43
  v_add_f32 v34, v34, v44
  v_add_f32 v35, v35, v45
  v_add_f32 v36, v36, v46
  v_add_f32 v37, v37, v47
  v_cvt_pk_bf16_f32 v56, v40, v41
  v_cvt_pk_bf16_f32 v57, v42, v43
  v_cvt_pk_bf16_f32 v58, v44, v45
  v_cvt_pk_bf16_f32 v59, v46, v47
  v_fma_f32 v40, v248, s76, -v33
  v_fma_f32 v41, v249, s76, -v33
  v_fma_f32 v42, v250, s76, -v33
  v_fma_f32 v43, v251, s76, -v33
  v_fma_f32 v44, v252, s76, -v33
  v_fma_f32 v45, v253, s76, -v33
  v_fma_f32 v46, v254, s76, -v33
  v_fma_f32 v47, v255, s76, -v33
  v_exp_f32 v40, v40
  v_exp_f32 v41, v41
  v_exp_f32 v42, v42
  v_exp_f32 v43, v43
  v_exp_f32 v44, v44
  v_exp_f32 v45, v45
  v_exp_f32 v46, v46
  v_exp_f32 v47, v47
  s_nop 0
  v_add_f32 v34, v34, v40
  v_add_f32 v35, v35, v41
  v_add_f32 v36, v36, v42
  v_add_f32 v37, v37, v43
  v_add_f32 v34, v34, v44
  v_add_f32 v35, v35, v45
  v_add_f32 v36, v36, v46
  v_add_f32 v37, v37, v47
  v_cvt_pk_bf16_f32 v60, v40, v41
  v_cvt_pk_bf16_f32 v61, v42, v43
  v_cvt_pk_bf16_f32 v62, v44, v45
  v_cvt_pk_bf16_f32 v63, v46, v47
  s_waitcnt vmcnt(8)
  s_barrier
  ds_read_b64_tr_b16 v[64:65], v18 offset:0
  ds_read_b64_tr_b16 v[66:67], v19 offset:0
  ds_read_b64_tr_b16 v[68:69], v20 offset:0
  ds_read_b64_tr_b16 v[70:71], v21 offset:0
  ds_read_b64_tr_b16 v[72:73], v22 offset:0
  ds_read_b64_tr_b16 v[74:75], v23 offset:0
  ds_read_b64_tr_b16 v[76:77], v24 offset:0
  ds_read_b64_tr_b16 v[78:79], v25 offset:0
  ds_read_b64_tr_b16 v[80:81], v18 offset:4096
  ds_read_b64_tr_b16 v[82:83], v19 offset:4096
  ds_read_b64_tr_b16 v[84:85], v20 offset:4096
  ds_read_b64_tr_b16 v[86:87], v21 offset:4096
  ds_read_b64_tr_b16 v[88:89], v22 offset:4096
  ds_read_b64_tr_b16 v[90:91], v23 offset:4096
  ds_read_b64_tr_b16 v[92:93], v24 offset:4096
  ds_read_b64_tr_b16 v[94:95], v25 offset:4096
  s_waitcnt lgkmcnt(14)
  v_mfma_f32_32x32x16_bf16 v[128:143], v[64:67], v[48:51], v[128:143]
  s_waitcnt lgkmcnt(12)
  v_mfma_f32_32x32x16_bf16 v[144:159], v[68:71], v[48:51], v[144:159]
  s_waitcnt lgkmcnt(10)
  v_mfma_f32_32x32x16_bf16 v[96:111], v[72:75], v[48:51], v[96:111]
  s_waitcnt lgkmcnt(8)
  v_mfma_f32_32x32x16_bf16 v[112:127], v[76:79], v[48:51], v[112:127]
  s_waitcnt lgkmcnt(6)
  v_mfma_f32_32x32x16_bf16 v[128:143], v[80:83], v[52:55], v[128:143]
  s_waitcnt lgkmcnt(4)
  v_mfma_f32_32x32x16_bf16 v[144:159], v[84:87], v[52:55], v[144:159]
  s_waitcnt lgkmcnt(2)
  v_mfma_f32_32x32x16_bf16 v[96:111], v[88:91], v[52:55], v[96:111]
  s_waitcnt lgkmcnt(0)
  v_mfma_f32_32x32x16_bf16 v[112:127], v[92:95], v[52:55], v[112:127]
  s_waitcnt vmcnt(0)
  s_barrier
  ds_read_b64_tr_b16 v[64:65], v18 offset:8192
  ds_read_b64_tr_b16 v[66:67], v19 offset:8192
  ds_read_b64_tr_b16 v[68:69], v20 offset:8192
  ds_read_b64_tr_b16 v[70:71], v21 offset:8192
  ds_read_b64_tr_b16 v[72:73], v22 offset:8192
  ds_read_b64_tr_b16 v[74:75], v23 offset:8192
  ds_read_b64_tr_b16 v[76:77], v24 offset:8192
  ds_read_b64_tr_b16 v[78:79], v25 offset:8192
  ds_read_b64_tr_b16 v[80:81], v18 offset:12288
  ds_read_b64_tr_b16 v[82:83], v19 offset:12288
  ds_read_b64_tr_b16 v[84:85], v20 offset:12288
  ds_read_b64_tr_b16 v[86:87], v21 offset:12288
  ds_read_b64_tr_b16 v[88:89], v22 offset:12288
  ds_read_b64_tr_b16 v[90:91], v23 offset:12288
  ds_read_b64_tr_b16 v[92:93], v24 offset:12288
  ds_read_b64_tr_b16 v[94:95], v25 offset:12288
  s_waitcnt lgkmcnt(14)
  v_mfma_f32_32x32x16_bf16 v[128:143], v[64:67], v[56:59], v[128:143]
  s_waitcnt lgkmcnt(12)
  v_mfma_f32_32x32x16_bf16 v[144:159], v[68:71], v[56:59], v[144:159]
  s_waitcnt lgkmcnt(10)
  v_mfma_f32_32x32x16_bf16 v[96:111], v[72:75], v[56:59], v[96:111]
  s_waitcnt lgkmcnt(8)
  v_mfma_f32_32x32x16_bf16 v[112:127], v[76:79], v[56:59], v[112:127]
  s_waitcnt lgkmcnt(6)
  v_mfma_f32_32x32x16_bf16 v[128:143], v[80:83], v[60:63], v[128:143]
  s_waitcnt lgkmcnt(4)
  v_mfma_f32_32x32x16_bf16 v[144:159], v[84:87], v[60:63], v[144:159]
  s_waitcnt lgkmcnt(2)
  v_mfma_f32_32x32x16_bf16 v[96:111], v[88:91], v[60:63], v[96:111]
  s_waitcnt lgkmcnt(0)
  v_mfma_f32_32x32x16_bf16 v[112:127], v[92:95], v[60:63], v[112:127]
  v_add_f32 v34, v34, v35
  v_add_f32 v36, v36, v37
  v_add_f32 v34, v34, v36
  v_mov_b32 v35, v34
  s_nop 1
  v_permlane32_swap_b32 v34, v35
  s_nop 1
  v_add_f32 v33, v34, v35
  s_nop 15
  v_add_u32 v27, s75, v5
  s_xor_b32 s78, s4, 1
  s_mul_i32 s78, s78, 16384
  s_add_u32 s78, s78, 98304
  v_add_u32 v28, s78, v5
  v_lshlrev_b32 v29, 3, v0
  v_add_u32 v1, s78, v29
  v_add_u32 v29, s75, v29
  ds_write_b64 v29, v[32:33] offset:8192
  s_and_b32 s79, s4, 1
  s_cmp_eq_u32 s79, 1
  s_cbranch_scc1 L_k1_g0_j1
  ds_write_b128 v27, v[96:99] offset:0
  ds_write_b128 v27, v[100:103] offset:1024
  ds_write_b128 v27, v[104:107] offset:2048
  ds_write_b128 v27, v[108:111] offset:3072
  ds_write_b128 v27, v[112:115] offset:4096
  ds_write_b128 v27, v[116:119] offset:5120
  ds_write_b128 v27, v[120:123] offset:6144
  ds_write_b128 v27, v[124:127] offset:7168
  s_branch L_k1_g0_jd
L_k1_g0_j1:
  ds_write_b128 v27, v[128:131] offset:0
  ds_write_b128 v27, v[132:135] offset:1024
  ds_write_b128 v27, v[136:139] offset:2048
  ds_write_b128 v27, v[140:143] offset:3072
  ds_write_b128 v27, v[144:147] offset:4096
  ds_write_b128 v27, v[148:151] offset:5120
  ds_write_b128 v27, v[152:155] offset:6144
  ds_write_b128 v27, v[156:159] offset:7168
  s_waitcnt lgkmcnt(0)
  v_mov_b32 v128, v96
  v_mov_b32 v129, v97
  v_mov_b32 v130, v98
  v_mov_b32 v131, v99
  v_mov_b32 v132, v100
  v_mov_b32 v133, v101
  v_mov_b32 v134, v102
  v_mov_b32 v135, v103
  v_mov_b32 v136, v104
  v_mov_b32 v137, v105
  v_mov_b32 v138, v106
  v_mov_b32 v139, v107
  v_mov_b32 v140, v108
  v_mov_b32 v141, v109
  v_mov_b32 v142, v110
  v_mov_b32 v143, v111
  v_mov_b32 v144, v112
  v_mov_b32 v145, v113
  v_mov_b32 v146, v114
  v_mov_b32 v147, v115
  v_mov_b32 v148, v116
  v_mov_b32 v149, v117
  v_mov_b32 v150, v118
  v_mov_b32 v151, v119
  v_mov_b32 v152, v120
  v_mov_b32 v153, v121
  v_mov_b32 v154, v122
  v_mov_b32 v155, v123
  v_mov_b32 v156, v124
  v_mov_b32 v157, v125
  v_mov_b32 v158, v126
  v_mov_b32 v159, v127
L_k1_g0_jd:
  s_waitcnt lgkmcnt(0)
  s_barrier
  ds_read_b64 v[34:35], v1 offset:8192
  ds_read_b128 v[64:67], v28 offset:0
  ds_read_b128 v[68:71], v28 offset:1024
  ds_read_b128 v[72:75], v28 offset:2048
  ds_read_b128 v[76:79], v28 offset:3072
  ds_read_b128 v[80:83], v28 offset:4096
  ds_read_b128 v[84:87], v28 offset:5120
  ds_read_b128 v[88:91], v28 offset:6144
  ds_read_b128 v[92:95], v28 offset:7168
  s_waitcnt lgkmcnt(8)
  v_max_f32 v36, v32, v34
  v_sub_f32 v37, v32, v36
  v_sub_f32 v38, v34, v36
  v_mul_f32 v37, s76, v37
  v_mul_f32 v38, s76, v38
  v_exp_f32 v37, v37
  v_exp_f32 v38, v38
  s_nop 0
  v_mul_f32 v39, v33, v37
  v_fma_f32 v39, v35, v38, v39
  v_rcp_f32 v39, v39
  s_nop 0
  v_mul_f32 v37, v37, v39
  v_mul_f32 v38, v38, v39
  s_lshl_b32 s77, s10, 5
  s_add_u32 s77, s77, s9
  s_lshl_b32 s77, s77, 14
  s_lshl_b32 s78, s4, 12
  s_add_u32 s77, s77, s78
  s_waitcnt lgkmcnt(0)
  v_mul_f32 v128, v128, v37
  v_fma_f32 v128, v64, v38, v128
  v_mul_f32 v129, v129, v37
  v_fma_f32 v129, v65, v38, v129
  v_mul_f32 v130, v130, v37
  v_fma_f32 v130, v66, v38, v130
  v_mul_f32 v131, v131, v37
  v_fma_f32 v131, v67, v38, v131
  v_mul_f32 v132, v132, v37
  v_fma_f32 v132, v68, v38, v132
  v_mul_f32 v133, v133, v37
  v_fma_f32 v133, v69, v38, v133
  v_mul_f32 v134, v134, v37
  v_fma_f32 v134, v70, v38, v134
  v_mul_f32 v135, v135, v37
  v_fma_f32 v135, v71, v38, v135
  v_mul_f32 v136, v136, v37
  v_fma_f32 v136, v72, v38, v136
  v_mul_f32 v137, v137, v37
  v_fma_f32 v137, v73, v38, v137
  v_mul_f32 v138, v138, v37
  v_fma_f32 v138, v74, v38, v138
  v_mul_f32 v139, v139, v37
  v_fma_f32 v139, v75, v38, v139
  v_mul_f32 v140, v140, v37
  v_fma_f32 v140, v76, v38, v140
  v_mul_f32 v141, v141, v37
  v_fma_f32 v141, v77, v38, v141
  v_mul_f32 v142, v142, v37
  v_fma_f32 v142, v78, v38, v142
  v_mul_f32 v143, v143, v37
  v_fma_f32 v143, v79, v38, v143
  v_mul_f32 v144, v144, v37
  v_fma_f32 v144, v80, v38, v144
  v_mul_f32 v145, v145, v37
  v_fma_f32 v145, v81, v38, v145
  v_mul_f32 v146, v146, v37
  v_fma_f32 v146, v82, v38, v146
  v_mul_f32 v147, v147, v37
  v_fma_f32 v147, v83, v38, v147
  v_mul_f32 v148, v148, v37
  v_fma_f32 v148, v84, v38, v148
  v_mul_f32 v149, v149, v37
  v_fma_f32 v149, v85, v38, v149
  v_mul_f32 v150, v150, v37
  v_fma_f32 v150, v86, v38, v150
  v_mul_f32 v151, v151, v37
  v_fma_f32 v151, v87, v38, v151
  v_mul_f32 v152, v152, v37
  v_fma_f32 v152, v88, v38, v152
  v_mul_f32 v153, v153, v37
  v_fma_f32 v153, v89, v38, v153
  v_mul_f32 v154, v154, v37
  v_fma_f32 v154, v90, v38, v154
  v_mul_f32 v155, v155, v37
  v_fma_f32 v155, v91, v38, v155
  v_mul_f32 v156, v156, v37
  v_fma_f32 v156, v92, v38, v156
  v_mul_f32 v157, v157, v37
  v_fma_f32 v157, v93, v38, v157
  v_mul_f32 v158, v158, v37
  v_fma_f32 v158, v94, v38, v158
  v_mul_f32 v159, v159, v37
  v_fma_f32 v159, v95, v38, v159
  v_cvt_pk_bf16_f32 v64, v128, v129
  v_cvt_pk_bf16_f32 v65, v130, v131
  v_cvt_pk_bf16_f32 v66, v132, v133
  v_cvt_pk_bf16_f32 v67, v134, v135
  v_cvt_pk_bf16_f32 v68, v136, v137
  v_cvt_pk_bf16_f32 v69, v138, v139
  v_cvt_pk_bf16_f32 v70, v140, v141
  v_cvt_pk_bf16_f32 v71, v142, v143
  v_cvt_pk_bf16_f32 v72, v144, v145
  v_cvt_pk_bf16_f32 v73, v146, v147
  v_cvt_pk_bf16_f32 v74, v148, v149
  v_cvt_pk_bf16_f32 v75, v150, v151
  v_cvt_pk_bf16_f32 v76, v152, v153
  v_cvt_pk_bf16_f32 v77, v154, v155
  v_cvt_pk_bf16_f32 v78, v156, v157
  v_cvt_pk_bf16_f32 v79, v158, v159
  buffer_store_dwordx4 v[64:67], v5, s[60:63], s77 offen offset:0 sc1
  buffer_store_dwordx4 v[68:71], v5, s[60:63], s77 offen offset:1024 sc1
  buffer_store_dwordx4 v[72:75], v5, s[60:63], s77 offen offset:2048 sc1
  buffer_store_dwordx4 v[76:79], v5, s[60:63], s77 offen offset:3072 sc1
  s_branch L_oproj
L_k1_B:
  s_mov_b32 s44, s16
  s_and_b32 s45, s17, 0xffff
  s_mov_b32 s46, 0x100000
  s_mov_b32 s47, 0x20000
  s_mov_b32 s48, s22
  s_and_b32 s49, s23, 0xffff
  s_mov_b32 s50, 0x800000
  s_mov_b32 s51, 0x20000
  s_lshl_b32 s73, s10, 17
  s_lshl_b32 s77, s4, 15
  s_add_u32 s73, s73, s77
  s_lshl_b32 s72, s9, 8
  s_lshl_b32 s77, s4, 17
  s_add_u32 s72, s72, s77
  s_lshr_b32 s77, s8, 3
  s_lshl_b32 s77, s77, 2
  s_and_b32 s78, s8, 7
  s_lshl_b32 s78, s78, 1
  s_add_u32 s77, s77, s78
  s_add_u32 s77, s77, 3
  s_and_b32 s77, s77, 15
  s_lshl_b32 s80, s77, 19
  s_lshl_b32 s81, s77, 7
  s_mov_b32 s52, s28
  s_and_b32 s53, s29, 0xffff
  s_mov_b32 s54, 0x4000000
  s_mov_b32 s55, 0x20000
  s_mov_b32 s56, s30
  s_and_b32 s57, s31, 0xffff
  s_mov_b32 s58, 0x4000000
  s_mov_b32 s59, 0x20000
  s_add_u32 s60, s40, 0x400000
  s_addc_u32 s61, s41, 0
  s_and_b32 s61, s61, 0xffff
  s_mov_b32 s62, 0x400000
  s_mov_b32 s63, 0x20000
  s_lshl_b32 s77, s12, 1
  s_lshr_b32 s78, s4, 1
  s_add_u32 s77, s77, s78
  s_lshl_b32 s78, s77, 5
  s_mov_b32 s79, s11
  s_add_u32 s78, s78, s79
  s_lshl_b32 s74, s78, 17
  s_and_b32 s78, s4, 1
  s_lshl_b32 s78, s78, 16
  s_add_u32 s74, s74, s78
  s_add_u32 s82, s11, s77
  s_and_b32 s82, s82, 7
  s_lshl_b32 s82, s82, 13
  s_mul_i32 s75, s4, 24576
  v_add_u32 v10, s75, v10
  v_add_u32 v18, s75, v18
  v_add_u32 v11, s75, v11
  v_add_u32 v19, s75, v19
  v_add_u32 v12, s75, v12
  v_add_u32 v20, s75, v20
  v_add_u32 v13, s75, v13
  v_add_u32 v21, s75, v21
  v_add_u32 v14, s75, v14
  v_add_u32 v22, s75, v22
  v_add_u32 v15, s75, v15
  v_add_u32 v23, s75, v23
  v_add_u32 v16, s75, v16
  v_add_u32 v24, s75, v24
  v_add_u32 v17, s75, v17
  v_add_u32 v25, s75, v25
  s_barrier
  ds_read_b64_tr_b16 v[128:129], v96 offset:32768
  ds_read_b64_tr_b16 v[130:131], v97 offset:32768
  ds_read_b128 v[132:135], v100 offset:16384
  ds_read_b128 v[136:139], v100 offset:20480
  ds_read_b64_tr_b16 v[140:141], v96 offset:36864
  ds_read_b64_tr_b16 v[142:143], v97 offset:36864
  ds_read_b128 v[144:147], v101 offset:16384
  ds_read_b128 v[148:151], v101 offset:20480
  ds_read_b64_tr_b16 v[152:153], v96 offset:40960
  ds_read_b64_tr_b16 v[154:155], v97 offset:40960
  ds_read_b128 v[156:159], v102 offset:16384
  ds_read_b128 v[160:163], v102 offset:20480
  ds_read_b64_tr_b16 v[164:165], v96 offset:45056
  ds_read_b64_tr_b16 v[166:167], v97 offset:45056
  ds_read_b128 v[168:171], v103 offset:16384
  ds_read_b128 v[172:175], v103 offset:20480
  s_waitcnt lgkmcnt(0)
  s_barrier
  v_mfma_f32_32x32x16_bf16 v[224:239], v[128:131], v[132:135], 0
  ds_read_b64_tr_b16 v[176:177], v96 offset:49152
  ds_read_b64_tr_b16 v[178:179], v97 offset:49152
  ds_read_b128 v[180:183], v100 offset:40960
  ds_read_b128 v[184:187], v100 offset:45056
  v_mfma_f32_32x32x16_bf16 v[240:255], v[128:131], v[136:139], 0
  ds_read_b64_tr_b16 v[188:189], v96 offset:53248
  ds_read_b64_tr_b16 v[190:191], v97 offset:53248
  ds_read_b128 v[192:195], v101 offset:40960
  ds_read_b128 v[196:199], v101 offset:45056
  v_mfma_f32_32x32x16_bf16 v[224:239], v[140:143], v[144:147], v[224:239]
  ds_read_b64_tr_b16 v[200:201], v96 offset:57344
  ds_read_b64_tr_b16 v[202:203], v97 offset:57344
  ds_read_b128 v[204:207], v102 offset:40960
  ds_read_b128 v[208:211], v102 offset:45056
  v_mfma_f32_32x32x16_bf16 v[240:255], v[140:143], v[148:151], v[240:255]
  ds_read_b64_tr_b16 v[212:213], v96 offset:61440
  ds_read_b64_tr_b16 v[214:215], v97 offset:61440
  ds_read_b128 v[216:219], v103 offset:40960
  ds_read_b128 v[220:223], v103 offset:45056
  v_mfma_f32_32x32x16_bf16 v[224:239], v[152:155], v[156:159], v[224:239]
  v_mfma_f32_32x32x16_bf16 v[240:255], v[152:155], v[160:163], v[240:255]
  v_mfma_f32_32x32x16_bf16 v[224:239], v[164:167], v[168:171], v[224:239]
  v_mfma_f32_32x32x16_bf16 v[240:255], v[164:167], v[172:175], v[240:255]
  s_waitcnt lgkmcnt(0)
  s_barrier
  v_mfma_f32_32x32x16_bf16 v[224:239], v[176:179], v[180:183], v[224:239]
  ds_read_b64_tr_b16 v[128:129], v98 offset:0
  ds_read_b64_tr_b16 v[130:131], v99 offset:0
  ds_read_b128 v[132:135], v104 offset:0
  ds_read_b128 v[136:139], v104 offset:4096
  v_mfma_f32_32x32x16_bf16 v[240:255], v[176:179], v[184:187], v[240:255]
  ds_read_b64_tr_b16 v[140:141], v98 offset:4096
  ds_read_b64_tr_b16 v[142:143], v99 offset:4096
  ds_read_b128 v[144:147], v105 offset:0
  ds_read_b128 v[148:151], v105 offset:4096
  v_mfma_f32_32x32x16_bf16 v[224:239], v[188:191], v[192:195], v[224:239]
  ds_read_b64_tr_b16 v[152:153], v98 offset:8192
  ds_read_b64_tr_b16 v[154:155], v99 offset:8192
  ds_read_b128 v[156:159], v106 offset:0
  ds_read_b128 v[160:163], v106 offset:4096
  v_mfma_f32_32x32x16_bf16 v[240:255], v[188:191], v[196:199], v[240:255]
  ds_read_b64_tr_b16 v[164:165], v98 offset:12288
  ds_read_b64_tr_b16 v[166:167], v99 offset:12288
  ds_read_b128 v[168:171], v107 offset:0
  ds_read_b128 v[172:175], v107 offset:4096
  v_mfma_f32_32x32x16_bf16 v[224:239], v[200:203], v[204:207], v[224:239]
  v_mfma_f32_32x32x16_bf16 v[240:255], v[200:203], v[208:211], v[240:255]
  v_mfma_f32_32x32x16_bf16 v[224:239], v[212:215], v[216:219], v[224:239]
  v_mfma_f32_32x32x16_bf16 v[240:255], v[212:215], v[220:223], v[240:255]
  s_add_u32 s77, s82, 0
  s_and_b32 s77, s77, 0xffff
  s_add_u32 s77, s77, s74
  s_add_u32 m0, s75, 0
  s_nop 0
  buffer_load_dwordx4 v6, s[52:55], s77 offen offset:0 nt lds
  buffer_load_dwordx4 v7, s[52:55], s77 offen offset:1024 nt lds
  buffer_load_dwordx4 v8, s[52:55], s77 offen offset:2048 nt lds
  buffer_load_dwordx4 v9, s[52:55], s77 offen offset:3072 nt lds
  s_add_u32 m0, s75, 4096
  s_add_u32 s77, s77, 4096
  buffer_load_dwordx4 v6, s[52:55], s77 offen offset:0 nt lds
  buffer_load_dwordx4 v7, s[52:55], s77 offen offset:1024 nt lds
  buffer_load_dwordx4 v8, s[52:55], s77 offen offset:2048 nt lds
  buffer_load_dwordx4 v9, s[52:55], s77 offen offset:3072 nt lds
  s_waitcnt lgkmcnt(0)
  s_barrier
  v_mfma_f32_32x32x16_bf16 v[224:239], v[128:131], v[132:135], v[224:239]
  ds_read_b64_tr_b16 v[176:177], v98 offset:16384
  ds_read_b64_tr_b16 v[178:179], v99 offset:16384
  ds_read_b128 v[180:183], v104 offset:24576
  ds_read_b128 v[184:187], v104 offset:28672
  v_mfma_f32_32x32x16_bf16 v[240:255], v[128:131], v[136:139], v[240:255]
  ds_read_b64_tr_b16 v[188:189], v98 offset:20480
  ds_read_b64_tr_b16 v[190:191], v99 offset:20480
  ds_read_b128 v[192:195], v105 offset:24576
  ds_read_b128 v[196:199], v105 offset:28672
  v_mfma_f32_32x32x16_bf16 v[224:239], v[140:143], v[144:147], v[224:239]
  ds_read_b64_tr_b16 v[200:201], v98 offset:24576
  ds_read_b64_tr_b16 v[202:203], v99 offset:24576
  ds_read_b128 v[204:207], v106 offset:24576
  ds_read_b128 v[208:211], v106 offset:28672
  v_mfma_f32_32x32x16_bf16 v[240:255], v[140:143], v[148:151], v[240:255]
  ds_read_b64_tr_b16 v[212:213], v98 offset:28672
  ds_read_b64_tr_b16 v[214:215], v99 offset:28672
  ds_read_b128 v[216:219], v107 offset:24576
  ds_read_b128 v[220:223], v107 offset:28672
  v_mfma_f32_32x32x16_bf16 v[224:239], v[152:155], v[156:159], v[224:239]
  v_mfma_f32_32x32x16_bf16 v[240:255], v[152:155], v[160:163], v[240:255]
  v_mfma_f32_32x32x16_bf16 v[224:239], v[164:167], v[168:171], v[224:239]
  v_mfma_f32_32x32x16_bf16 v[240:255], v[164:167], v[172:175], v[240:255]
  s_waitcnt lgkmcnt(0)
  s_barrier
  v_mfma_f32_32x32x16_bf16 v[224:239], v[176:179], v[180:183], v[224:239]
  ds_read_b64_tr_b16 v[128:129], v96 offset:32768
  ds_read_b64_tr_b16 v[130:131], v97 offset:32768
  ds_read_b128 v[132:135], v100 offset:16384
  ds_read_b128 v[136:139], v100 offset:20480
  v_mfma_f32_32x32x16_bf16 v[240:255], v[176:179], v[184:187], v[240:255]
  ds_read_b64_tr_b16 v[140:141], v96 offset:36864
  ds_read_b64_tr_b16 v[142:143], v97 offset:36864
  ds_read_b128 v[144:147], v101 offset:16384
  ds_read_b128 v[148:151], v101 offset:20480
  v_mfma_f32_32x32x16_bf16 v[224:239], v[188:191], v[192:195], v[224:239]
  ds_read_b64_tr_b16 v[152:153], v96 offset:40960
  ds_read_b64_tr_b16 v[154:155], v97 offset:40960
  ds_read_b128 v[156:159], v102 offset:16384
  ds_read_b128 v[160:163], v102 offset:20480
  v_mfma_f32_32x32x16_bf16 v[240:255], v[188:191], v[196:199], v[240:255]
  ds_read_b64_tr_b16 v[164:165], v96 offset:45056
  ds_read_b64_tr_b16 v[166:167], v97 offset:45056
  ds_read_b128 v[168:171], v103 offset:16384
  ds_read_b128 v[172:175], v103 offset:20480
  v_mfma_f32_32x32x16_bf16 v[224:239], v[200:203], v[204:207], v[224:239]
  v_mfma_f32_32x32x16_bf16 v[240:255], v[200:203], v[208:211], v[240:255]
  v_mfma_f32_32x32x16_bf16 v[224:239], v[212:215], v[216:219], v[224:239]
  v_mfma_f32_32x32x16_bf16 v[240:255], v[212:215], v[220:223], v[240:255]
  s_waitcnt lgkmcnt(0)
  s_barrier
  v_mfma_f32_32x32x16_bf16 v[224:239], v[128:131], v[132:135], v[224:239]
  ds_read_b64_tr_b16 v[176:177], v96 offset:49152
  ds_read_b64_tr_b16 v[178:179], v97 offset:49152
  ds_read_b128 v[180:183], v100 offset:40960
  ds_read_b128 v[184:187], v100 offset:45056
  v_mfma_f32_32x32x16_bf16 v[240:255], v[128:131], v[136:139], v[240:255]
  ds_read_b64_tr_b16 v[188:189], v96 offset:53248
  ds_read_b64_tr_b16 v[190:191], v97 offset:53248
  ds_read_b128 v[192:195], v101 offset:40960
  ds_read_b128 v[196:199], v101 offset:45056
  v_mfma_f32_32x32x16_bf16 v[224:239], v[140:143], v[144:147], v[224:239]
  ds_read_b64_tr_b16 v[200:201], v96 offset:57344
  ds_read_b64_tr_b16 v[202:203], v97 offset:57344
  ds_read_b128 v[204:207], v102 offset:40960
  ds_read_b128 v[208:211], v102 offset:45056
  v_mfma_f32_32x32x16_bf16 v[240:255], v[140:143], v[148:151], v[240:255]
  ds_read_b64_tr_b16 v[212:213], v96 offset:61440
  ds_read_b64_tr_b16 v[214:215], v97 offset:61440
  ds_read_b128 v[216:219], v103 offset:40960
  ds_read_b128 v[220:223], v103 offset:45056
  v_mfma_f32_32x32x16_bf16 v[224:239], v[152:155], v[156:159], v[224:239]
  v_mfma_f32_32x32x16_bf16 v[240:255], v[152:155], v[160:163], v[240:255]
  v_mfma_f32_32x32x16_bf16 v[224:239], v[164:167], v[168:171], v[224:239]
  v_mfma_f32_32x32x16_bf16 v[240:255], v[164:167], v[172:175], v[240:255]
  s_waitcnt lgkmcnt(0)
  s_barrier
  v_mfma_f32_32x32x16_bf16 v[224:239], v[176:179], v[180:183], v[224:239]
  ds_read_b64_tr_b16 v[128:129], v98 offset:0
  ds_read_b64_tr_b16 v[130:131], v99 offset:0
  ds_read_b128 v[132:135], v104 offset:0
  ds_read_b128 v[136:139], v104 offset:4096
  v_mfma_f32_32x32x16_bf16 v[240:255], v[176:179], v[184:187], v[240:255]
  ds_read_b64_tr_b16 v[140:141], v98 offset:4096
  ds_read_b64_tr_b16 v[142:143], v99 offset:4096
  ds_read_b128 v[144:147], v105 offset:0
  ds_read_b128 v[148:151], v105 offset:4096
  v_mfma_f32_32x32x16_bf16 v[224:239], v[188:191], v[192:195], v[224:239]
  ds_read_b64_tr_b16 v[152:153], v98 offset:8192
  ds_read_b64_tr_b16 v[154:155], v99 offset:8192
  ds_read_b128 v[156:159], v106 offset:0
  ds_read_b128 v[160:163], v106 offset:4096
  v_mfma_f32_32x32x16_bf16 v[240:255], v[188:191], v[196:199], v[240:255]
  ds_read_b64_tr_b16 v[164:165], v98 offset:12288
  ds_read_b64_tr_b16 v[166:167], v99 offset:12288
  ds_read_b128 v[168:171], v107 offset:0
  ds_read_b128 v[172:175], v107 offset:4096
  v_mfma_f32_32x32x16_bf16 v[224:239], v[200:203], v[204:207], v[224:239]
  v_mfma_f32_32x32x16_bf16 v[240:255], v[200:203], v[208:211], v[240:255]
  v_mfma_f32_32x32x16_bf16 v[224:239], v[212:215], v[216:219], v[224:239]
  v_mfma_f32_32x32x16_bf16 v[240:255], v[212:215], v[220:223], v[240:255]
  s_add_u32 s77, s82, 8192
  s_and_b32 s77, s77, 0xffff
  s_add_u32 s77, s77, s74
  s_add_u32 m0, s75, 8192
  s_nop 0
  buffer_load_dwordx4 v6, s[52:55], s77 offen offset:0 nt lds
  buffer_load_dwordx4 v7, s[52:55], s77 offen offset:1024 nt lds
  buffer_load_dwordx4 v8, s[52:55], s77 offen offset:2048 nt lds
  buffer_load_dwordx4 v9, s[52:55], s77 offen offset:3072 nt lds
  s_add_u32 m0, s75, 12288
  s_add_u32 s77, s77, 4096
  buffer_load_dwordx4 v6, s[52:55], s77 offen offset:0 nt lds
  buffer_load_dwordx4 v7, s[52:55], s77 offen offset:1024 nt lds
  buffer_load_dwordx4 v8, s[52:55], s77 offen offset:2048 nt lds
  buffer_load_dwordx4 v9, s[52:55], s77 offen offset:3072 nt lds
  s_waitcnt lgkmcnt(0)
  s_barrier
  v_mfma_f32_32x32x16_bf16 v[224:239], v[128:131], v[132:135], v[224:239]
  ds_read_b64_tr_b16 v[176:177], v98 offset:16384
  ds_read_b64_tr_b16 v[178:179], v99 offset:16384
  ds_read_b128 v[180:183], v104 offset:24576
  ds_read_b128 v[184:187], v104 offset:28672
  v_mfma_f32_32x32x16_bf16 v[240:255], v[128:131], v[136:139], v[240:255]
  ds_read_b64_tr_b16 v[188:189], v98 offset:20480
  ds_read_b64_tr_b16 v[190:191], v99 offset:20480
  ds_read_b128 v[192:195], v105 offset:24576
  ds_read_b128 v[196:199], v105 offset:28672
  v_mfma_f32_32x32x16_bf16 v[224:239], v[140:143], v[144:147], v[224:239]
  ds_read_b64_tr_b16 v[200:201], v98 offset:24576
  ds_read_b64_tr_b16 v[202:203], v99 offset:24576
  ds_read_b128 v[204:207], v106 offset:24576
  ds_read_b128 v[208:211], v106 offset:28672
  v_mfma_f32_32x32x16_bf16 v[240:255], v[140:143], v[148:151], v[240:255]
  ds_read_b64_tr_b16 v[212:213], v98 offset:28672
  ds_read_b64_tr_b16 v[214:215], v99 offset:28672
  ds_read_b128 v[216:219], v107 offset:24576
  ds_read_b128 v[220:223], v107 offset:28672
  v_mfma_f32_32x32x16_bf16 v[224:239], v[152:155], v[156:159], v[224:239]
  v_mfma_f32_32x32x16_bf16 v[240:255], v[152:155], v[160:163], v[240:255]
  v_mfma_f32_32x32x16_bf16 v[224:239], v[164:167], v[168:171], v[224:239]
  v_mfma_f32_32x32x16_bf16 v[240:255], v[164:167], v[172:175], v[240:255]
  s_waitcnt lgkmcnt(0)
  s_barrier
  v_mfma_f32_32x32x16_bf16 v[224:239], v[176:179], v[180:183], v[224:239]
  ds_read_b64_tr_b16 v[128:129], v96 offset:32768
  ds_read_b64_tr_b16 v[130:131], v97 offset:32768
  ds_read_b128 v[132:135], v100 offset:16384
  ds_read_b128 v[136:139], v100 offset:20480
  v_mfma_f32_32x32x16_bf16 v[240:255], v[176:179], v[184:187], v[240:255]
  ds_read_b64_tr_b16 v[140:141], v96 offset:36864
  ds_read_b64_tr_b16 v[142:143], v97 offset:36864
  ds_read_b128 v[144:147], v101 offset:16384
  ds_read_b128 v[148:151], v101 offset:20480
  v_mfma_f32_32x32x16_bf16 v[224:239], v[188:191], v[192:195], v[224:239]
  ds_read_b64_tr_b16 v[152:153], v96 offset:40960
  ds_read_b64_tr_b16 v[154:155], v97 offset:40960
  ds_read_b128 v[156:159], v102 offset:16384
  ds_read_b128 v[160:163], v102 offset:20480
  v_mfma_f32_32x32x16_bf16 v[240:255], v[188:191], v[196:199], v[240:255]
  ds_read_b64_tr_b16 v[164:165], v96 offset:45056
  ds_read_b64_tr_b16 v[166:167], v97 offset:45056
  ds_read_b128 v[168:171], v103 offset:16384
  ds_read_b128 v[172:175], v103 offset:20480
  v_mfma_f32_32x32x16_bf16 v[224:239], v[200:203], v[204:207], v[224:239]
  v_mfma_f32_32x32x16_bf16 v[240:255], v[200:203], v[208:211], v[240:255]
  v_mfma_f32_32x32x16_bf16 v[224:239], v[212:215], v[216:219], v[224:239]
  v_mfma_f32_32x32x16_bf16 v[240:255], v[212:215], v[220:223], v[240:255]
  s_waitcnt lgkmcnt(0)
  s_barrier
  v_mfma_f32_32x32x16_bf16 v[224:239], v[128:131], v[132:135], v[224:239]
  ds_read_b64_tr_b16 v[176:177], v96 offset:49152
  ds_read_b64_tr_b16 v[178:179], v97 offset:49152
  ds_read_b128 v[180:183], v100 offset:40960
  ds_read_b128 v[184:187], v100 offset:45056
  v_mfma_f32_32x32x16_bf16 v[240:255], v[128:131], v[136:139], v[240:255]
  ds_read_b64_tr_b16 v[188:189], v96 offset:53248
  ds_read_b64_tr_b16 v[190:191], v97 offset:53248
  ds_read_b128 v[192:195], v101 offset:40960
  ds_read_b128 v[196:199], v101 offset:45056
  v_mfma_f32_32x32x16_bf16 v[224:239], v[140:143], v[144:147], v[224:239]
  ds_read_b64_tr_b16 v[200:201], v96 offset:57344
  ds_read_b64_tr_b16 v[202:203], v97 offset:57344
  ds_read_b128 v[204:207], v102 offset:40960
  ds_read_b128 v[208:211], v102 offset:45056
  v_mfma_f32_32x32x16_bf16 v[240:255], v[140:143], v[148:151], v[240:255]
  ds_read_b64_tr_b16 v[212:213], v96 offset:61440
  ds_read_b64_tr_b16 v[214:215], v97 offset:61440
  ds_read_b128 v[216:219], v103 offset:40960
  ds_read_b128 v[220:223], v103 offset:45056
  v_mfma_f32_32x32x16_bf16 v[224:239], v[152:155], v[156:159], v[224:239]
  v_mfma_f32_32x32x16_bf16 v[240:255], v[152:155], v[160:163], v[240:255]
  v_mfma_f32_32x32x16_bf16 v[224:239], v[164:167], v[168:171], v[224:239]
  v_mfma_f32_32x32x16_bf16 v[240:255], v[164:167], v[172:175], v[240:255]
  s_waitcnt lgkmcnt(0)
  s_barrier
  v_mfma_f32_32x32x16_bf16 v[224:239], v[176:179], v[180:183], v[224:239]
  ds_read_b64_tr_b16 v[128:129], v98 offset:0
  ds_read_b64_tr_b16 v[130:131], v99 offset:0
  ds_read_b128 v[132:135], v104 offset:0
  ds_read_b128 v[136:139], v104 offset:4096
  v_mfma_f32_32x32x16_bf16 v[240:255], v[176:179], v[184:187], v[240:255]
  ds_read_b64_tr_b16 v[140:141], v98 offset:4096
  ds_read_b64_tr_b16 v[142:143], v99 offset:4096
  ds_read_b128 v[144:147], v105 offset:0
  ds_read_b128 v[148:151], v105 offset:4096
  v_mfma_f32_32x32x16_bf16 v[224:239], v[188:191], v[192:195], v[224:239]
  ds_read_b64_tr_b16 v[152:153], v98 offset:8192
  ds_read_b64_tr_b16 v[154:155], v99 offset:8192
  ds_read_b128 v[156:159], v106 offset:0
  ds_read_b128 v[160:163], v106 offset:4096
  v_mfma_f32_32x32x16_bf16 v[240:255], v[188:191], v[196:199], v[240:255]
  ds_read_b64_tr_b16 v[164:165], v98 offset:12288
  ds_read_b64_tr_b16 v[166:167], v99 offset:12288
  ds_read_b128 v[168:171], v107 offset:0
  ds_read_b128 v[172:175], v107 offset:4096
  v_mfma_f32_32x32x16_bf16 v[224:239], v[200:203], v[204:207], v[224:239]
  v_mfma_f32_32x32x16_bf16 v[240:255], v[200:203], v[208:211], v[240:255]
  v_mfma_f32_32x32x16_bf16 v[224:239], v[212:215], v[216:219], v[224:239]
  v_mfma_f32_32x32x16_bf16 v[240:255], v[212:215], v[220:223], v[240:255]
  s_waitcnt lgkmcnt(0)
  s_barrier
  v_mfma_f32_32x32x16_bf16 v[224:239], v[128:131], v[132:135], v[224:239]
  ds_read_b64_tr_b16 v[176:177], v98 offset:16384
  ds_read_b64_tr_b16 v[178:179], v99 offset:16384
  ds_read_b128 v[180:183], v104 offset:24576
  ds_read_b128 v[184:187], v104 offset:28672
  v_mfma_f32_32x32x16_bf16 v[240:255], v[128:131], v[136:139], v[240:255]
  ds_read_b64_tr_b16 v[188:189], v98 offset:20480
  ds_read_b64_tr_b16 v[190:191], v99 offset:20480
  ds_read_b128 v[192:195], v105 offset:24576
  ds_read_b128 v[196:199], v105 offset:28672
  v_mfma_f32_32x32x16_bf16 v[224:239], v[140:143], v[144:147], v[224:239]
  ds_read_b64_tr_b16 v[200:201], v98 offset:24576
  ds_read_b64_tr_b16 v[202:203], v99 offset:24576
  ds_read_b128 v[204:207], v106 offset:24576
  ds_read_b128 v[208:211], v106 offset:28672
  v_mfma_f32_32x32x16_bf16 v[240:255], v[140:143], v[148:151], v[240:255]
  ds_read_b64_tr_b16 v[212:213], v98 offset:28672
  ds_read_b64_tr_b16 v[214:215], v99 offset:28672
  ds_read_b128 v[216:219], v107 offset:24576
  ds_read_b128 v[220:223], v107 offset:28672
  v_mfma_f32_32x32x16_bf16 v[224:239], v[152:155], v[156:159], v[224:239]
  v_mfma_f32_32x32x16_bf16 v[240:255], v[152:155], v[160:163], v[240:255]
  v_mfma_f32_32x32x16_bf16 v[224:239], v[164:167], v[168:171], v[224:239]
  v_mfma_f32_32x32x16_bf16 v[240:255], v[164:167], v[172:175], v[240:255]
  s_waitcnt lgkmcnt(0)
  s_barrier
  v_mfma_f32_32x32x16_bf16 v[224:239], v[176:179], v[180:183], v[224:239]
  ds_read_b64_tr_b16 v[128:129], v96 offset:32768
  ds_read_b64_tr_b16 v[130:131], v97 offset:32768
  ds_read_b128 v[132:135], v100 offset:16384
  ds_read_b128 v[136:139], v100 offset:20480
  v_mfma_f32_32x32x16_bf16 v[240:255], v[176:179], v[184:187], v[240:255]
  ds_read_b64_tr_b16 v[140:141], v96 offset:36864
  ds_read_b64_tr_b16 v[142:143], v97 offset:36864
  ds_read_b128 v[144:147], v101 offset:16384
  ds_read_b128 v[148:151], v101 offset:20480
  v_mfma_f32_32x32x16_bf16 v[224:239], v[188:191], v[192:195], v[224:239]
  ds_read_b64_tr_b16 v[152:153], v96 offset:40960
  ds_read_b64_tr_b16 v[154:155], v97 offset:40960
  ds_read_b128 v[156:159], v102 offset:16384
  ds_read_b128 v[160:163], v102 offset:20480
  v_mfma_f32_32x32x16_bf16 v[240:255], v[188:191], v[196:199], v[240:255]
  ds_read_b64_tr_b16 v[164:165], v96 offset:45056
  ds_read_b64_tr_b16 v[166:167], v97 offset:45056
  ds_read_b128 v[168:171], v103 offset:16384
  ds_read_b128 v[172:175], v103 offset:20480
  v_mfma_f32_32x32x16_bf16 v[224:239], v[200:203], v[204:207], v[224:239]
  v_mfma_f32_32x32x16_bf16 v[240:255], v[200:203], v[208:211], v[240:255]
  v_mfma_f32_32x32x16_bf16 v[224:239], v[212:215], v[216:219], v[224:239]
  v_mfma_f32_32x32x16_bf16 v[240:255], v[212:215], v[220:223], v[240:255]
  s_waitcnt lgkmcnt(0)
  s_barrier
  v_mfma_f32_32x32x16_bf16 v[224:239], v[128:131], v[132:135], v[224:239]
  ds_read_b64_tr_b16 v[176:177], v96 offset:49152
  ds_read_b64_tr_b16 v[178:179], v97 offset:49152
  ds_read_b128 v[180:183], v100 offset:40960
  ds_read_b128 v[184:187], v100 offset:45056
  v_mfma_f32_32x32x16_bf16 v[240:255], v[128:131], v[136:139], v[240:255]
  ds_read_b64_tr_b16 v[188:189], v96 offset:53248
  ds_read_b64_tr_b16 v[190:191], v97 offset:53248
  ds_read_b128 v[192:195], v101 offset:40960
  ds_read_b128 v[196:199], v101 offset:45056
  v_mfma_f32_32x32x16_bf16 v[224:239], v[140:143], v[144:147], v[224:239]
  ds_read_b64_tr_b16 v[200:201], v96 offset:57344
  ds_read_b64_tr_b16 v[202:203], v97 offset:57344
  ds_read_b128 v[204:207], v102 offset:40960
  ds_read_b128 v[208:211], v102 offset:45056
  v_mfma_f32_32x32x16_bf16 v[240:255], v[140:143], v[148:151], v[240:255]
  ds_read_b64_tr_b16 v[212:213], v96 offset:61440
  ds_read_b64_tr_b16 v[214:215], v97 offset:61440
  ds_read_b128 v[216:219], v103 offset:40960
  ds_read_b128 v[220:223], v103 offset:45056
  v_mfma_f32_32x32x16_bf16 v[224:239], v[152:155], v[156:159], v[224:239]
  v_mfma_f32_32x32x16_bf16 v[240:255], v[152:155], v[160:163], v[240:255]
  v_mfma_f32_32x32x16_bf16 v[224:239], v[164:167], v[168:171], v[224:239]
  v_mfma_f32_32x32x16_bf16 v[240:255], v[164:167], v[172:175], v[240:255]
  s_waitcnt lgkmcnt(0)
  s_barrier
  v_mfma_f32_32x32x16_bf16 v[224:239], v[176:179], v[180:183], v[224:239]
  ds_read_b64_tr_b16 v[128:129], v98 offset:0
  ds_read_b64_tr_b16 v[130:131], v99 offset:0
  ds_read_b128 v[132:135], v104 offset:0
  ds_read_b128 v[136:139], v104 offset:4096
  v_mfma_f32_32x32x16_bf16 v[240:255], v[176:179], v[184:187], v[240:255]
  ds_read_b64_tr_b16 v[140:141], v98 offset:4096
  ds_read_b64_tr_b16 v[142:143], v99 offset:4096
  ds_read_b128 v[144:147], v105 offset:0
  ds_read_b128 v[148:151], v105 offset:4096
  v_mfma_f32_32x32x16_bf16 v[224:239], v[188:191], v[192:195], v[224:239]
  ds_read_b64_tr_b16 v[152:153], v98 offset:8192
  ds_read_b64_tr_b16 v[154:155], v99 offset:8192
  ds_read_b128 v[156:159], v106 offset:0
  ds_read_b128 v[160:163], v106 offset:4096
  v_mfma_f32_32x32x16_bf16 v[240:255], v[188:191], v[196:199], v[240:255]
  ds_read_b64_tr_b16 v[164:165], v98 offset:12288
  ds_read_b64_tr_b16 v[166:167], v99 offset:12288
  ds_read_b128 v[168:171], v107 offset:0
  ds_read_b128 v[172:175], v107 offset:4096
  v_mfma_f32_32x32x16_bf16 v[224:239], v[200:203], v[204:207], v[224:239]
  v_mfma_f32_32x32x16_bf16 v[240:255], v[200:203], v[208:211], v[240:255]
  v_mfma_f32_32x32x16_bf16 v[224:239], v[212:215], v[216:219], v[224:239]
  v_mfma_f32_32x32x16_bf16 v[240:255], v[212:215], v[220:223], v[240:255]
  s_waitcnt lgkmcnt(0)
  s_barrier
  v_mfma_f32_32x32x16_bf16 v[224:239], v[128:131], v[132:135], v[224:239]
  ds_read_b64_tr_b16 v[176:177], v98 offset:16384
  ds_read_b64_tr_b16 v[178:179], v99 offset:16384
  ds_read_b128 v[180:183], v104 offset:24576
  ds_read_b128 v[184:187], v104 offset:28672
  v_mfma_f32_32x32x16_bf16 v[240:255], v[128:131], v[136:139], v[240:255]
  ds_read_b64_tr_b16 v[188:189], v98 offset:20480
  ds_read_b64_tr_b16 v[190:191], v99 offset:20480
  ds_read_b128 v[192:195], v105 offset:24576
  ds_read_b128 v[196:199], v105 offset:28672
  v_mfma_f32_32x32x16_bf16 v[224:239], v[140:143], v[144:147], v[224:239]
  ds_read_b64_tr_b16 v[200:201], v98 offset:24576
  ds_read_b64_tr_b16 v[202:203], v99 offset:24576
  ds_read_b128 v[204:207], v106 offset:24576
  ds_read_b128 v[208:211], v106 offset:28672
  v_mfma_f32_32x32x16_bf16 v[240:255], v[140:143], v[148:151], v[240:255]
  ds_read_b64_tr_b16 v[212:213], v98 offset:28672
  ds_read_b64_tr_b16 v[214:215], v99 offset:28672
  ds_read_b128 v[216:219], v107 offset:24576
  ds_read_b128 v[220:223], v107 offset:28672
  v_mfma_f32_32x32x16_bf16 v[224:239], v[152:155], v[156:159], v[224:239]
  v_mfma_f32_32x32x16_bf16 v[240:255], v[152:155], v[160:163], v[240:255]
  v_mfma_f32_32x32x16_bf16 v[224:239], v[164:167], v[168:171], v[224:239]
  v_mfma_f32_32x32x16_bf16 v[240:255], v[164:167], v[172:175], v[240:255]
  s_waitcnt lgkmcnt(0)
  s_barrier
  v_mfma_f32_32x32x16_bf16 v[224:239], v[176:179], v[180:183], v[224:239]
  v_mfma_f32_32x32x16_bf16 v[240:255], v[176:179], v[184:187], v[240:255]
  v_mfma_f32_32x32x16_bf16 v[224:239], v[188:191], v[192:195], v[224:239]
  v_mfma_f32_32x32x16_bf16 v[240:255], v[188:191], v[196:199], v[240:255]
  v_mfma_f32_32x32x16_bf16 v[224:239], v[200:203], v[204:207], v[224:239]
  v_mfma_f32_32x32x16_bf16 v[240:255], v[200:203], v[208:211], v[240:255]
  v_mfma_f32_32x32x16_bf16 v[224:239], v[212:215], v[216:219], v[224:239]
  v_mfma_f32_32x32x16_bf16 v[240:255], v[212:215], v[220:223], v[240:255]
  s_add_u32 m0, s84, 90112
  s_add_u32 s77, s73, s81
  buffer_load_dwordx4 v84, s[44:47], s77 offen lds
  buffer_load_dwordx4 v85, s[44:47], s77 offen offset:1024 lds
  s_add_u32 m0, s83, 147456
  s_add_u32 s77, s72, s80
  buffer_load_dwordx4 v80, s[48:51], s77 offen offset:0 lds
  buffer_load_dwordx4 v81, s[48:51], s77 offen offset:1024 lds
  buffer_load_dwordx4 v82, s[48:51], s77 offen offset:2048 lds
  buffer_load_dwordx4 v83, s[48:51], s77 offen offset:3072 lds
  s_add_u32 s81, s81, 128
  s_and_b32 s81, s81, 2047
  s_add_u32 s80, s80, 0x80000
  s_and_b32 s80, s80, 0x7fffff
  s_barrier
  s_add_u32 m0, s84, 16384
  s_add_u32 s77, s73, s81
  buffer_load_dwordx4 v84, s[44:47], s77 offen lds
  buffer_load_dwordx4 v85, s[44:47], s77 offen offset:1024 lds
  s_add_u32 m0, s83, 98304
  s_add_u32 s77, s72, s80
  buffer_load_dwordx4 v80, s[48:51], s77 offen offset:0 lds
  buffer_load_dwordx4 v81, s[48:51], s77 offen offset:1024 lds
  buffer_load_dwordx4 v82, s[48:51], s77 offen offset:2048 lds
  buffer_load_dwordx4 v83, s[48:51], s77 offen offset:3072 lds
  s_add_u32 s81, s81, 128
  s_and_b32 s81, s81, 2047
  s_add_u32 s80, s80, 0x80000
  s_and_b32 s80, s80, 0x7fffff
  v_cvt_pk_bf16_f32 v64, v224, v225
  v_cvt_pk_bf16_f32 v65, v226, v227
  v_cvt_pk_bf16_f32 v66, v228, v229
  v_cvt_pk_bf16_f32 v67, v230, v231
  v_cvt_pk_bf16_f32 v68, v232, v233
  v_cvt_pk_bf16_f32 v69, v234, v235
  v_cvt_pk_bf16_f32 v70, v236, v237
  v_cvt_pk_bf16_f32 v71, v238, v239
  v_cvt_pk_bf16_f32 v72, v240, v241
  v_cvt_pk_bf16_f32 v73, v242, v243
  v_cvt_pk_bf16_f32 v74, v244, v245
  v_cvt_pk_bf16_f32 v75, v246, v247
  v_cvt_pk_bf16_f32 v76, v248, v249
  v_cvt_pk_bf16_f32 v77, v250, v251
  v_cvt_pk_bf16_f32 v78, v252, v253
  v_cvt_pk_bf16_f32 v79, v254, v255
  s_barrier
  s_add_u32 m0, s84, 40960
  s_add_u32 s77, s73, s81
  buffer_load_dwordx4 v84, s[44:47], s77 offen lds
  buffer_load_dwordx4 v85, s[44:47], s77 offen offset:1024 lds
  s_add_u32 m0, s83, 114688
  s_add_u32 s77, s72, s80
  buffer_load_dwordx4 v80, s[48:51], s77 offen offset:0 lds
  buffer_load_dwordx4 v81, s[48:51], s77 offen offset:1024 lds
  buffer_load_dwordx4 v82, s[48:51], s77 offen offset:2048 lds
  buffer_load_dwordx4 v83, s[48:51], s77 offen offset:3072 lds
  s_add_u32 s81, s81, 128
  s_and_b32 s81, s81, 2047
  s_add_u32 s80, s80, 0x80000
  s_and_b32 s80, s80, 0x7fffff
  s_waitcnt vmcnt(12)
  s_barrier
  s_add_u32 m0, s84, 65536
  s_add_u32 s77, s73, s81
  buffer_load_dwordx4 v84, s[44:47], s77 offen lds
  buffer_load_dwordx4 v85, s[44:47], s77 offen offset:1024 lds
  s_add_u32 m0, s83, 131072
  s_add_u32 s77, s72, s80
  buffer_load_dwordx4 v80, s[48:51], s77 offen offset:0 lds
  buffer_load_dwordx4 v81, s[48:51], s77 offen offset:1024 lds
  buffer_load_dwordx4 v82, s[48:51], s77 offen offset:2048 lds
  buffer_load_dwordx4 v83, s[48:51], s77 offen offset:3072 lds
  s_add_u32 s81, s81, 128
  s_and_b32 s81, s81, 2047
  s_add_u32 s80, s80, 0x80000
  s_and_b32 s80, s80, 0x7fffff
  s_waitcnt vmcnt(12)
  s_barrier
  s_add_u32 m0, s84, 90112
  s_add_u32 s77, s73, s81
  buffer_load_dwordx4 v84, s[44:47], s77 offen lds
  buffer_load_dwordx4 v85, s[44:47], s77 offen offset:1024 lds
  s_add_u32 m0, s83, 147456
  s_add_u32 s77, s72, s80
  buffer_load_dwordx4 v80, s[48:51], s77 offen offset:0 lds
  buffer_load_dwordx4 v81, s[48:51], s77 offen offset:1024 lds
  buffer_load_dwordx4 v82, s[48:51], s77 offen offset:2048 lds
  buffer_load_dwordx4 v83, s[48:51], s77 offen offset:3072 lds
  s_add_u32 s81, s81, 128
  s_and_b32 s81, s81, 2047
  s_add_u32 s80, s80, 0x80000
  s_and_b32 s80, s80, 0x7fffff
  s_waitcnt vmcnt(12)
  s_barrier
  s_add_u32 m0, s84, 16384
  s_add_u32 s77, s73, s81
  buffer_load_dwordx4 v84, s[44:47], s77 offen lds
  buffer_load_dwordx4 v85, s[44:47], s77 offen offset:1024 lds
  s_add_u32 m0, s83, 98304
  s_add_u32 s77, s72, s80
  buffer_load_dwordx4 v80, s[48:51], s77 offen offset:0 lds
  buffer_load_dwordx4 v81, s[48:51], s77 offen offset:1024 lds
  buffer_load_dwordx4 v82, s[48:51], s77 offen offset:2048 lds
  buffer_load_dwordx4 v83, s[48:51], s77 offen offset:3072 lds
  s_add_u32 s81, s81, 128
  s_and_b32 s81, s81, 2047
  s_add_u32 s80, s80, 0x80000
  s_and_b32 s80, s80, 0x7fffff
  s_add_u32 s77, s82, 16384
  s_and_b32 s77, s77, 0xffff
  s_add_u32 s77, s77, s74
  buffer_load_dwordx4 v[128:131], v6, s[52:55], s77 offen offset:0 nt
  buffer_load_dwordx4 v[132:135], v7, s[52:55], s77 offen offset:1024 nt
  buffer_load_dwordx4 v[136:139], v8, s[52:55], s77 offen offset:2048 nt
  buffer_load_dwordx4 v[140:143], v9, s[52:55], s77 offen offset:3072 nt
  s_add_u32 s77, s77, 4096
  buffer_load_dwordx4 v[144:147], v6, s[52:55], s77 offen offset:0 nt
  buffer_load_dwordx4 v[148:151], v7, s[52:55], s77 offen offset:1024 nt
  buffer_load_dwordx4 v[152:155], v8, s[52:55], s77 offen offset:2048 nt
  buffer_load_dwordx4 v[156:159], v9, s[52:55], s77 offen offset:3072 nt
  s_waitcnt vmcnt(20)
  s_barrier
  s_add_u32 m0, s84, 40960
  s_add_u32 s77, s73, s81
  buffer_load_dwordx4 v84, s[44:47], s77 offen lds
  buffer_load_dwordx4 v85, s[44:47], s77 offen offset:1024 lds
  s_add_u32 m0, s83, 114688
  s_add_u32 s77, s72, s80
  buffer_load_dwordx4 v80, s[48:51], s77 offen offset:0 lds
  buffer_load_dwordx4 v81, s[48:51], s77 offen offset:1024 lds
  buffer_load_dwordx4 v82, s[48:51], s77 offen offset:2048 lds
  buffer_load_dwordx4 v83, s[48:51], s77 offen offset:3072 lds
  s_add_u32 s81, s81, 128
  s_and_b32 s81, s81, 2047
  s_add_u32 s80, s80, 0x80000
  s_and_b32 s80, s80, 0x7fffff
  s_waitcnt vmcnt(20)
  s_barrier
  s_add_u32 m0, s84, 65536
  s_add_u32 s77, s73, s81
  buffer_load_dwordx4 v84, s[44:47], s77 offen lds
  buffer_load_dwordx4 v85, s[44:47], s77 offen offset:1024 lds
  s_add_u32 m0, s83, 131072
  s_add_u32 s77, s72, s80
  buffer_load_dwordx4 v80, s[48:51], s77 offen offset:0 lds
  buffer_load_dwordx4 v81, s[48:51], s77 offen offset:1024 lds
  buffer_load_dwordx4 v82, s[48:51], s77 offen offset:2048 lds
  buffer_load_dwordx4 v83, s[48:51], s77 offen offset:3072 lds
  s_add_u32 s81, s81, 128
  s_and_b32 s81, s81, 2047
  s_add_u32 s80, s80, 0x80000
  s_and_b32 s80, s80, 0x7fffff
  s_waitcnt vmcnt(20)
  s_barrier
  s_add_u32 m0, s84, 90112
  s_add_u32 s77, s73, s81
  buffer_load_dwordx4 v84, s[44:47], s77 offen lds
  buffer_load_dwordx4 v85, s[44:47], s77 offen offset:1024 lds
  s_add_u32 m0, s83, 147456
  s_add_u32 s77, s72, s80
  buffer_load_dwordx4 v80, s[48:51], s77 offen offset:0 lds
  buffer_load_dwordx4 v81, s[48:51], s77 offen offset:1024 lds
  buffer_load_dwordx4 v82, s[48:51], s77 offen offset:2048 lds
  buffer_load_dwordx4 v83, s[48:51], s77 offen offset:3072 lds
  s_add_u32 s81, s81, 128
  s_and_b32 s81, s81, 2047
  s_add_u32 s80, s80, 0x80000
  s_and_b32 s80, s80, 0x7fffff
  s_add_u32 s77, s82, 24576
  s_and_b32 s77, s77, 0xffff
  s_add_u32 s77, s77, s74
  buffer_load_dwordx4 v[160:163], v6, s[52:55], s77 offen offset:0 nt
  buffer_load_dwordx4 v[164:167], v7, s[52:55], s77 offen offset:1024 nt
  buffer_load_dwordx4 v[168:171], v8, s[52:55], s77 offen offset:2048 nt
  buffer_load_dwordx4 v[172:175], v9, s[52:55], s77 offen offset:3072 nt
  s_add_u32 s77, s77, 4096
  buffer_load_dwordx4 v[176:179], v6, s[52:55], s77 offen offset:0 nt
  buffer_load_dwordx4 v[180:183], v7, s[52:55], s77 offen offset:1024 nt
  buffer_load_dwordx4 v[184:187], v8, s[52:55], s77 offen offset:2048 nt
  buffer_load_dwordx4 v[188:191], v9, s[52:55], s77 offen offset:3072 nt
  s_waitcnt vmcnt(20)
  s_barrier
  s_add_u32 m0, s84, 16384
  s_add_u32 s77, s73, s81
  buffer_load_dwordx4 v84, s[44:47], s77 offen lds
  buffer_load_dwordx4 v85, s[44:47], s77 offen offset:1024 lds
  s_add_u32 m0, s83, 98304
  s_add_u32 s77, s72, s80
  buffer_load_dwordx4 v80, s[48:51], s77 offen offset:0 lds
  buffer_load_dwordx4 v81, s[48:51], s77 offen offset:1024 lds
  buffer_load_dwordx4 v82, s[48:51], s77 offen offset:2048 lds
  buffer_load_dwordx4 v83, s[48:51], s77 offen offset:3072 lds
  s_add_u32 s81, s81, 128
  s_and_b32 s81, s81, 2047
  s_add_u32 s80, s80, 0x80000
  s_and_b32 s80, s80, 0x7fffff
  s_waitcnt vmcnt(20)
  s_barrier
  s_add_u32 m0, s84, 40960
  s_add_u32 s77, s73, s81
  buffer_load_dwordx4 v84, s[44:47], s77 offen lds
  buffer_load_dwordx4 v85, s[44:47], s77 offen offset:1024 lds
  s_add_u32 m0, s83, 114688
  s_add_u32 s77, s72, s80
  buffer_load_dwordx4 v80, s[48:51], s77 offen offset:0 lds
  buffer_load_dwordx4 v81, s[48:51], s77 offen offset:1024 lds
  buffer_load_dwordx4 v82, s[48:51], s77 offen offset:2048 lds
  buffer_load_dwordx4 v83, s[48:51], s77 offen offset:3072 lds
  s_add_u32 s81, s81, 128
  s_and_b32 s81, s81, 2047
  s_add_u32 s80, s80, 0x80000
  s_and_b32 s80, s80, 0x7fffff
  s_waitcnt vmcnt(20)
  s_barrier
  s_add_u32 m0, s84, 65536
  s_add_u32 s77, s73, s81
  buffer_load_dwordx4 v84, s[44:47], s77 offen lds
  buffer_load_dwordx4 v85, s[44:47], s77 offen offset:1024 lds
  s_add_u32 m0, s83, 131072
  s_add_u32 s77, s72, s80
  buffer_load_dwordx4 v80, s[48:51], s77 offen offset:0 lds
  buffer_load_dwordx4 v81, s[48:51], s77 offen offset:1024 lds
  buffer_load_dwordx4 v82, s[48:51], s77 offen offset:2048 lds
  buffer_load_dwordx4 v83, s[48:51], s77 offen offset:3072 lds
  s_add_u32 s81, s81, 128
  s_and_b32 s81, s81, 2047
  s_add_u32 s80, s80, 0x80000
  s_and_b32 s80, s80, 0x7fffff
  s_add_u32 s77, s82, 32768
  s_and_b32 s77, s77, 0xffff
  s_add_u32 s77, s77, s74
  buffer_load_dwordx4 v[192:195], v6, s[52:55], s77 offen offset:0 nt
  buffer_load_dwordx4 v[196:199], v7, s[52:55], s77 offen offset:1024 nt
  buffer_load_dwordx4 v[200:203], v8, s[52:55], s77 offen offset:2048 nt
  buffer_load_dwordx4 v[204:207], v9, s[52:55], s77 offen offset:3072 nt
  s_add_u32 s77, s77, 4096
  buffer_load_dwordx4 v[208:211], v6, s[52:55], s77 offen offset:0 nt
  buffer_load_dwordx4 v[212:215], v7, s[52:55], s77 offen offset:1024 nt
  buffer_load_dwordx4 v[216:219], v8, s[52:55], s77 offen offset:2048 nt
  buffer_load_dwordx4 v[220:223], v9, s[52:55], s77 offen offset:3072 nt
  s_waitcnt vmcnt(20)
  s_barrier
  s_add_u32 m0, s84, 90112
  s_add_u32 s77, s73, s81
  buffer_load_dwordx4 v84, s[44:47], s77 offen lds
  buffer_load_dwordx4 v85, s[44:47], s77 offen offset:1024 lds
  s_add_u32 m0, s83, 147456
  s_add_u32 s77, s72, s80
  buffer_load_dwordx4 v80, s[48:51], s77 offen offset:0 lds
  buffer_load_dwordx4 v81, s[48:51], s77 offen offset:1024 lds
  buffer_load_dwordx4 v82, s[48:51], s77 offen offset:2048 lds
  buffer_load_dwordx4 v83, s[48:51], s77 offen offset:3072 lds
  s_add_u32 s81, s81, 128
  s_and_b32 s81, s81, 2047
  s_add_u32 s80, s80, 0x80000
  s_and_b32 s80, s80, 0x7fffff
  s_waitcnt vmcnt(20)
  s_barrier
  s_waitcnt vmcnt(14)
  s_barrier
  s_add_u32 s77, s82, 40960
  s_and_b32 s77, s77, 0xffff
  s_add_u32 s77, s77, s74
  buffer_load_dwordx4 v[224:227], v6, s[52:55], s77 offen offset:0 nt
  buffer_load_dwordx4 v[228:231], v7, s[52:55], s77 offen offset:1024 nt
  buffer_load_dwordx4 v[232:235], v8, s[52:55], s77 offen offset:2048 nt
  buffer_load_dwordx4 v[236:239], v9, s[52:55], s77 offen offset:3072 nt
  s_add_u32 s77, s77, 4096
  buffer_load_dwordx4 v[240:243], v6, s[52:55], s77 offen offset:0 nt
  buffer_load_dwordx4 v[244:247], v7, s[52:55], s77 offen offset:1024 nt
  buffer_load_dwordx4 v[248:251], v8, s[52:55], s77 offen offset:2048 nt
  buffer_load_dwordx4 v[252:255], v9, s[52:55], s77 offen offset:3072 nt
  s_waitcnt vmcnt(8)
  s_barrier
  ds_write_b128 v86, v[64:67] offset:0
  ds_write_b128 v86, v[68:71] offset:1024
  ds_write_b128 v86, v[72:75] offset:8192
  ds_write_b128 v86, v[76:79] offset:9216
  s_lshr_b32 s78, s4, 1
  s_lshl_b32 s78, s78, 13
  s_add_u32 s78, s78, 114688
  v_add_u32 v26, s78, v5
  s_waitcnt lgkmcnt(0)
  s_barrier
  ds_read_b128 v[32:35], v26 offset:0
  ds_read_b128 v[36:39], v26 offset:1024
  ds_read_b128 v[40:43], v26 offset:2048
  ds_read_b128 v[44:47], v26 offset:3072
  ds_read_b128 v[48:51], v26 offset:4096
  ds_read_b128 v[52:55], v26 offset:5120
  ds_read_b128 v[56:59], v26 offset:6144
  ds_read_b128 v[60:63], v26 offset:7168
  s_waitcnt lgkmcnt(0)
  s_barrier
  s_waitcnt vmcnt(63)
  v_add_u32 v1, s75, v5
  ds_write_b128 v1, v[128:131] offset:16384
  ds_write_b128 v1, v[132:135] offset:17408
  ds_write_b128 v1, v[136:139] offset:18432
  ds_write_b128 v1, v[140:143] offset:19456
  ds_write_b128 v1, v[144:147] offset:20480
  ds_write_b128 v1, v[148:151] offset:21504
  ds_write_b128 v1, v[152:155] offset:22528
  ds_write_b128 v1, v[156:159] offset:23552
  s_waitcnt vmcnt(63)
  ds_read_b128 v[64:67], v10 offset:0
  ds_read_b128 v[68:71], v11 offset:0
  ds_read_b128 v[72:75], v12 offset:0
  ds_read_b128 v[76:79], v13 offset:0
  ds_read_b128 v[80:83], v14 offset:0
  ds_read_b128 v[84:87], v15 offset:0
  ds_read_b128 v[88:91], v16 offset:0
  ds_read_b128 v[92:95], v17 offset:0
  s_waitcnt lgkmcnt(7)
  v_mfma_f32_32x32x16_bf16 v[128:143], v[64:67], v[32:35], 0
  s_waitcnt lgkmcnt(6)
  v_mfma_f32_32x32x16_bf16 v[128:143], v[68:71], v[36:39], v[128:143]
  s_waitcnt lgkmcnt(5)
  v_mfma_f32_32x32x16_bf16 v[128:143], v[72:75], v[40:43], v[128:143]
  s_waitcnt lgkmcnt(4)
  v_mfma_f32_32x32x16_bf16 v[128:143], v[76:79], v[44:47], v[128:143]
  s_waitcnt lgkmcnt(3)
  v_mfma_f32_32x32x16_bf16 v[128:143], v[80:83], v[48:51], v[128:143]
  s_waitcnt lgkmcnt(2)
  v_mfma_f32_32x32x16_bf16 v[128:143], v[84:87], v[52:55], v[128:143]
  s_waitcnt lgkmcnt(1)
  v_mfma_f32_32x32x16_bf16 v[128:143], v[88:91], v[56:59], v[128:143]
  s_waitcnt lgkmcnt(0)
  v_mfma_f32_32x32x16_bf16 v[128:143], v[92:95], v[60:63], v[128:143]
  s_waitcnt vmcnt(40)
  v_add_u32 v1, s75, v5
  ds_write_b128 v1, v[160:163] offset:0
  ds_write_b128 v1, v[164:167] offset:1024
  ds_write_b128 v1, v[168:171] offset:2048
  ds_write_b128 v1, v[172:175] offset:3072
  ds_write_b128 v1, v[176:179] offset:4096
  ds_write_b128 v1, v[180:183] offset:5120
  ds_write_b128 v1, v[184:187] offset:6144
  ds_write_b128 v1, v[188:191] offset:7168
  s_waitcnt vmcnt(63)
  ds_read_b128 v[64:67], v10 offset:8192
  ds_read_b128 v[68:71], v11 offset:8192
  ds_read_b128 v[72:75], v12 offset:8192
  ds_read_b128 v[76:79], v13 offset:8192
  ds_read_b128 v[80:83], v14 offset:8192
  ds_read_b128 v[84:87], v15 offset:8192
  ds_read_b128 v[88:91], v16 offset:8192
  ds_read_b128 v[92:95], v17 offset:8192
  v_max3_f32 v26, v128, v129, v130
  v_max3_f32 v26, v26, v131, v132
  v_max3_f32 v26, v26, v133, v134
  v_max_f32 v26, v26, v135
  v_max3_f32 v27, v136, v137, v138
  v_max3_f32 v27, v27, v139, v140
  v_max3_f32 v27, v27, v141, v142
  v_max_f32 v27, v27, v143
  s_waitcnt lgkmcnt(7)
  v_mfma_f32_32x32x16_bf16 v[144:159], v[64:67], v[32:35], 0
  s_waitcnt lgkmcnt(6)
  v_mfma_f32_32x32x16_bf16 v[144:159], v[68:71], v[36:39], v[144:159]
  s_waitcnt lgkmcnt(5)
  v_mfma_f32_32x32x16_bf16 v[144:159], v[72:75], v[40:43], v[144:159]
  s_waitcnt lgkmcnt(4)
  v_mfma_f32_32x32x16_bf16 v[144:159], v[76:79], v[44:47], v[144:159]
  s_waitcnt lgkmcnt(3)
  v_mfma_f32_32x32x16_bf16 v[144:159], v[80:83], v[48:51], v[144:159]
  s_waitcnt lgkmcnt(2)
  v_mfma_f32_32x32x16_bf16 v[144:159], v[84:87], v[52:55], v[144:159]
  s_waitcnt lgkmcnt(1)
  v_mfma_f32_32x32x16_bf16 v[144:159], v[88:91], v[56:59], v[144:159]
  s_waitcnt lgkmcnt(0)
  v_mfma_f32_32x32x16_bf16 v[144:159], v[92:95], v[60:63], v[144:159]
  s_waitcnt vmcnt(14)
  v_add_u32 v1, s75, v5
  ds_write_b128 v1, v[192:195] offset:8192
  ds_write_b128 v1, v[196:199] offset:9216
  ds_write_b128 v1, v[200:203] offset:10240
  ds_write_b128 v1, v[204:207] offset:11264
  ds_write_b128 v1, v[208:211] offset:12288
  ds_write_b128 v1, v[212:215] offset:13312
  ds_write_b128 v1, v[216:219] offset:14336
  ds_write_b128 v1, v[220:223] offset:15360
  s_waitcnt vmcnt(63)
  ds_read_b128 v[64:67], v10 offset:16384
  ds_read_b128 v[68:71], v11 offset:16384
  ds_read_b128 v[72:75], v12 offset:16384
  ds_read_b128 v[76:79], v13 offset:16384
  ds_read_b128 v[80:83], v14 offset:16384
  ds_read_b128 v[84:87], v15 offset:16384
  ds_read_b128 v[88:91], v16 offset:16384
  ds_read_b128 v[92:95], v17 offset:16384
  v_max3_f32 v26, v26, v144, v145
  v_max3_f32 v26, v26, v146, v147
  v_max3_f32 v26, v26, v148, v149
  v_max3_f32 v26, v26, v150, v151
  v_max3_f32 v27, v27, v152, v153
  v_max3_f32 v27, v27, v154, v155
  v_max3_f32 v27, v27, v156, v157
  v_max3_f32 v27, v27, v158, v159
  s_waitcnt lgkmcnt(7)
  v_mfma_f32_32x32x16_bf16 v[160:175], v[64:67], v[32:35], 0
  s_waitcnt lgkmcnt(6)
  v_mfma_f32_32x32x16_bf16 v[160:175], v[68:71], v[36:39], v[160:175]
  s_waitcnt lgkmcnt(5)
  v_mfma_f32_32x32x16_bf16 v[160:175], v[72:75], v[40:43], v[160:175]
  s_waitcnt lgkmcnt(4)
  v_mfma_f32_32x32x16_bf16 v[160:175], v[76:79], v[44:47], v[160:175]
  s_waitcnt lgkmcnt(3)
  v_mfma_f32_32x32x16_bf16 v[160:175], v[80:83], v[48:51], v[160:175]
  s_waitcnt lgkmcnt(2)
  v_mfma_f32_32x32x16_bf16 v[160:175], v[84:87], v[52:55], v[160:175]
  s_waitcnt lgkmcnt(1)
  v_mfma_f32_32x32x16_bf16 v[160:175], v[88:91], v[56:59], v[160:175]
  s_waitcnt lgkmcnt(0)
  v_mfma_f32_32x32x16_bf16 v[160:175], v[92:95], v[60:63], v[160:175]
  s_waitcnt vmcnt(0)
  v_add_u32 v1, s75, v5
  ds_write_b128 v1, v[224:227] offset:16384
  ds_write_b128 v1, v[228:231] offset:17408
  ds_write_b128 v1, v[232:235] offset:18432
  ds_write_b128 v1, v[236:239] offset:19456
  ds_write_b128 v1, v[240:243] offset:20480
  ds_write_b128 v1, v[244:247] offset:21504
  ds_write_b128 v1, v[248:251] offset:22528
  ds_write_b128 v1, v[252:255] offset:23552
  s_waitcnt vmcnt(40)
  ds_read_b128 v[64:67], v10 offset:0
  ds_read_b128 v[68:71], v11 offset:0
  ds_read_b128 v[72:75], v12 offset:0
  ds_read_b128 v[76:79], v13 offset:0
  ds_read_b128 v[80:83], v14 offset:0
  ds_read_b128 v[84:87], v15 offset:0
  ds_read_b128 v[88:91], v16 offset:0
  ds_read_b128 v[92:95], v17 offset:0
  v_max3_f32 v26, v26, v160, v161
  v_max3_f32 v26, v26, v162, v163
  v_max3_f32 v26, v26, v164, v165
  v_max3_f32 v26, v26, v166, v167
  v_max3_f32 v27, v27, v168, v169
  v_max3_f32 v27, v27, v170, v171
  v_max3_f32 v27, v27, v172, v173
  v_max3_f32 v27, v27, v174, v175
  s_waitcnt lgkmcnt(7)
  v_mfma_f32_32x32x16_bf16 v[176:191], v[64:67], v[32:35], 0
  s_waitcnt lgkmcnt(6)
  v_mfma_f32_32x32x16_bf16 v[176:191], v[68:71], v[36:39], v[176:191]
  s_waitcnt lgkmcnt(5)
  v_mfma_f32_32x32x16_bf16 v[176:191], v[72:75], v[40:43], v[176:191]
  s_waitcnt lgkmcnt(4)
  v_mfma_f32_32x32x16_bf16 v[176:191], v[76:79], v[44:47], v[176:191]
  s_waitcnt lgkmcnt(3)
  v_mfma_f32_32x32x16_bf16 v[176:191], v[80:83], v[48:51], v[176:191]
  s_waitcnt lgkmcnt(2)
  v_mfma_f32_32x32x16_bf16 v[176:191], v[84:87], v[52:55], v[176:191]
  s_waitcnt lgkmcnt(1)
  v_mfma_f32_32x32x16_bf16 v[176:191], v[88:91], v[56:59], v[176:191]
  s_waitcnt lgkmcnt(0)
  v_mfma_f32_32x32x16_bf16 v[176:191], v[92:95], v[60:63], v[176:191]
  s_add_u32 s77, s82, 49152
  s_and_b32 s77, s77, 0xffff
  s_add_u32 s77, s77, s74
  s_add_u32 m0, s75, 0
  s_nop 0
  buffer_load_dwordx4 v6, s[52:55], s77 offen offset:0 nt lds
  buffer_load_dwordx4 v7, s[52:55], s77 offen offset:1024 nt lds
  buffer_load_dwordx4 v8, s[52:55], s77 offen offset:2048 nt lds
  buffer_load_dwordx4 v9, s[52:55], s77 offen offset:3072 nt lds
  s_add_u32 m0, s75, 4096
  s_add_u32 s77, s77, 4096
  buffer_load_dwordx4 v6, s[52:55], s77 offen offset:0 nt lds
  buffer_load_dwordx4 v7, s[52:55], s77 offen offset:1024 nt lds
  buffer_load_dwordx4 v8, s[52:55], s77 offen offset:2048 nt lds
  buffer_load_dwordx4 v9, s[52:55], s77 offen offset:3072 nt lds
  s_waitcnt vmcnt(22)
  ds_read_b128 v[64:67], v10 offset:8192
  ds_read_b128 v[68:71], v11 offset:8192
  ds_read_b128 v[72:75], v12 offset:8192
  ds_read_b128 v[76:79], v13 offset:8192
  ds_read_b128 v[80:83], v14 offset:8192
  ds_read_b128 v[84:87], v15 offset:8192
  ds_read_b128 v[88:91], v16 offset:8192
  ds_read_b128 v[92:95], v17 offset:8192
  v_max3_f32 v26, v26, v176, v177
  v_max3_f32 v26, v26, v178, v179
  v_max3_f32 v26, v26, v180, v181
  v_max3_f32 v26, v26, v182, v183
  v_max3_f32 v27, v27, v184, v185
  v_max3_f32 v27, v27, v186, v187
  v_max3_f32 v27, v27, v188, v189
  v_max3_f32 v27, v27, v190, v191
  s_waitcnt lgkmcnt(7)
  v_mfma_f32_32x32x16_bf16 v[192:207], v[64:67], v[32:35], 0
  s_waitcnt lgkmcnt(6)
  v_mfma_f32_32x32x16_bf16 v[192:207], v[68:71], v[36:39], v[192:207]
  s_waitcnt lgkmcnt(5)
  v_mfma_f32_32x32x16_bf16 v[192:207], v[72:75], v[40:43], v[192:207]
  s_waitcnt lgkmcnt(4)
  v_mfma_f32_32x32x16_bf16 v[192:207], v[76:79], v[44:47], v[192:207]
  s_waitcnt lgkmcnt(3)
  v_mfma_f32_32x32x16_bf16 v[192:207], v[80:83], v[48:51], v[192:207]
  s_waitcnt lgkmcnt(2)
  v_mfma_f32_32x32x16_bf16 v[192:207], v[84:87], v[52:55], v[192:207]
  s_waitcnt lgkmcnt(1)
  v_mfma_f32_32x32x16_bf16 v[192:207], v[88:91], v[56:59], v[192:207]
  s_waitcnt lgkmcnt(0)
  v_mfma_f32_32x32x16_bf16 v[192:207], v[92:95], v[60:63], v[192:207]
  s_add_u32 s77, s82, 57344
  s_and_b32 s77, s77, 0xffff
  s_add_u32 s77, s77, s74
  s_add_u32 m0, s75, 8192
  s_nop 0
  buffer_load_dwordx4 v6, s[52:55], s77 offen offset:0 nt lds
  buffer_load_dwordx4 v7, s[52:55], s77 offen offset:1024 nt lds
  buffer_load_dwordx4 v8, s[52:55], s77 offen offset:2048 nt lds
  buffer_load_dwordx4 v9, s[52:55], s77 offen offset:3072 nt lds
  s_add_u32 m0, s75, 12288
  s_add_u32 s77, s77, 4096
  buffer_load_dwordx4 v6, s[52:55], s77 offen offset:0 nt lds
  buffer_load_dwordx4 v7, s[52:55], s77 offen offset:1024 nt lds
  buffer_load_dwordx4 v8, s[52:55], s77 offen offset:2048 nt lds
  buffer_load_dwordx4 v9, s[52:55], s77 offen offset:3072 nt lds
  s_waitcnt vmcnt(16)
  ds_read_b128 v[64:67], v10 offset:16384
  ds_read_b128 v[68:71], v11 offset:16384
  ds_read_b128 v[72:75], v12 offset:16384
  ds_read_b128 v[76:79], v13 offset:16384
  ds_read_b128 v[80:83], v14 offset:16384
  ds_read_b128 v[84:87], v15 offset:16384
  ds_read_b128 v[88:91], v16 offset:16384
  ds_read_b128 v[92:95], v17 offset:16384
  v_max3_f32 v26, v26, v192, v193
  v_max3_f32 v26, v26, v194, v195
  v_max3_f32 v26, v26, v196, v197
  v_max3_f32 v26, v26, v198, v199
  v_max3_f32 v27, v27, v200, v201
  v_max3_f32 v27, v27, v202, v203
  v_max3_f32 v27, v27, v204, v205
  v_max3_f32 v27, v27, v206, v207
  s_waitcnt lgkmcnt(7)
  v_mfma_f32_32x32x16_bf16 v[208:223], v[64:67], v[32:35], 0
  s_waitcnt lgkmcnt(6)
  v_mfma_f32_32x32x16_bf16 v[208:223], v[68:71], v[36:39], v[208:223]
  s_waitcnt lgkmcnt(5)
  v_mfma_f32_32x32x16_bf16 v[208:223], v[72:75], v[40:43], v[208:223]
  s_waitcnt lgkmcnt(4)
  v_mfma_f32_32x32x16_bf16 v[208:223], v[76:79], v[44:47], v[208:223]
  s_waitcnt lgkmcnt(3)
  v_mfma_f32_32x32x16_bf16 v[208:223], v[80:83], v[48:51], v[208:223]
  s_waitcnt lgkmcnt(2)
  v_mfma_f32_32x32x16_bf16 v[208:223], v[84:87], v[52:55], v[208:223]
  s_waitcnt lgkmcnt(1)
  v_mfma_f32_32x32x16_bf16 v[208:223], v[88:91], v[56:59], v[208:223]
  s_waitcnt lgkmcnt(0)
  v_mfma_f32_32x32x16_bf16 v[208:223], v[92:95], v[60:63], v[208:223]
  s_add_u32 s77, s82, 0
  s_and_b32 s77, s77, 0xffff
  s_add_u32 s77, s77, s74
  s_add_u32 m0, s75, 16384
  s_nop 0
  buffer_load_dwordx4 v6, s[56:59], s77 offen offset:0 nt lds
  buffer_load_dwordx4 v7, s[56:59], s77 offen offset:1024 nt lds
  buffer_load_dwordx4 v8, s[56:59], s77 offen offset:2048 nt lds
  buffer_load_dwordx4 v9, s[56:59], s77 offen offset:3072 nt lds
  s_add_u32 m0, s75, 20480
  s_add_u32 s77, s77, 4096
  buffer_load_dwordx4 v6, s[56:59], s77 offen offset:0 nt lds
  buffer_load_dwordx4 v7, s[56:59], s77 offen offset:1024 nt lds
  buffer_load_dwordx4 v8, s[56:59], s77 offen offset:2048 nt lds
  buffer_load_dwordx4 v9, s[56:59], s77 offen offset:3072 nt lds
  s_waitcnt vmcnt(16)
  s_barrier
  ds_read_b128 v[64:67], v10 offset:0
  ds_read_b128 v[68:71], v11 offset:0
  ds_read_b128 v[72:75], v12 offset:0
  ds_read_b128 v[76:79], v13 offset:0
  ds_read_b128 v[80:83], v14 offset:0
  ds_read_b128 v[84:87], v15 offset:0
  ds_read_b128 v[88:91], v16 offset:0
  ds_read_b128 v[92:95], v17 offset:0
  v_max3_f32 v26, v26, v208, v209
  v_max3_f32 v26, v26, v210, v211
  v_max3_f32 v26, v26, v212, v213
  v_max3_f32 v26, v26, v214, v215
  v_max3_f32 v27, v27, v216, v217
  v_max3_f32 v27, v27, v218, v219
  v_max3_f32 v27, v27, v220, v221
  v_max3_f32 v27, v27, v222, v223
  s_waitcnt lgkmcnt(7)
  v_mfma_f32_32x32x16_bf16 v[224:239], v[64:67], v[32:35], 0
  s_waitcnt lgkmcnt(6)
  v_mfma_f32_32x32x16_bf16 v[224:239], v[68:71], v[36:39], v[224:239]
  s_waitcnt lgkmcnt(5)
  v_mfma_f32_32x32x16_bf16 v[224:239], v[72:75], v[40:43], v[224:239]
  s_waitcnt lgkmcnt(4)
  v_mfma_f32_32x32x16_bf16 v[224:239], v[76:79], v[44:47], v[224:239]
  s_waitcnt lgkmcnt(3)
  v_mfma_f32_32x32x16_bf16 v[224:239], v[80:83], v[48:51], v[224:239]
  s_waitcnt lgkmcnt(2)
  v_mfma_f32_32x32x16_bf16 v[224:239], v[84:87], v[52:55], v[224:239]
  s_waitcnt lgkmcnt(1)
  v_mfma_f32_32x32x16_bf16 v[224:239], v[88:91], v[56:59], v[224:239]
  s_waitcnt lgkmcnt(0)
  v_mfma_f32_32x32x16_bf16 v[224:239], v[92:95], v[60:63], v[224:239]
  s_add_u32 s77, s82, 8192
  s_and_b32 s77, s77, 0xffff
  s_add_u32 s77, s77, s74
  s_add_u32 m0, s75, 0
  s_nop 0
  buffer_load_dwordx4 v6, s[56:59], s77 offen offset:0 nt lds
  buffer_load_dwordx4 v7, s[56:59], s77 offen offset:1024 nt lds
  buffer_load_dwordx4 v8, s[56:59], s77 offen offset:2048 nt lds
  buffer_load_dwordx4 v9, s[56:59], s77 offen offset:3072 nt lds
  s_add_u32 m0, s75, 4096
  s_add_u32 s77, s77, 4096
  buffer_load_dwordx4 v6, s[56:59], s77 offen offset:0 nt lds
  buffer_load_dwordx4 v7, s[56:59], s77 offen offset:1024 nt lds
  buffer_load_dwordx4 v8, s[56:59], s77 offen offset:2048 nt lds
  buffer_load_dwordx4 v9, s[56:59], s77 offen offset:3072 nt lds
  s_waitcnt vmcnt(16)
  s_barrier
  ds_read_b128 v[64:67], v10 offset:8192
  ds_read_b128 v[68:71], v11 offset:8192
  ds_read_b128 v[72:75], v12 offset:8192
  ds_read_b128 v[76:79], v13 offset:8192
  ds_read_b128 v[80:83], v14 offset:8192
  ds_read_b128 v[84:87], v15 offset:8192
  ds_read_b128 v[88:91], v16 offset:8192
  ds_read_b128 v[92:95], v17 offset:8192
  v_max3_f32 v26, v26, v224, v225
  v_max3_f32 v26, v26, v226, v227
  v_max3_f32 v26, v26, v228, v229
  v_max3_f32 v26, v26, v230, v231
  v_max3_f32 v27, v27, v232, v233
  v_max3_f32 v27, v27, v234, v235
  v_max3_f32 v27, v27, v236, v237
  v_max3_f32 v27, v27, v238, v239
  s_waitcnt lgkmcnt(7)
  v_mfma_f32_32x32x16_bf16 v[240:255], v[64:67], v[32:35], 0
  s_waitcnt lgkmcnt(6)
  v_mfma_f32_32x32x16_bf16 v[240:255], v[68:71], v[36:39], v[240:255]
  s_waitcnt lgkmcnt(5)
  v_mfma_f32_32x32x16_bf16 v[240:255], v[72:75], v[40:43], v[240:255]
  s_waitcnt lgkmcnt(4)
  v_mfma_f32_32x32x16_bf16 v[240:255], v[76:79], v[44:47], v[240:255]
  s_waitcnt lgkmcnt(3)
  v_mfma_f32_32x32x16_bf16 v[240:255], v[80:83], v[48:51], v[240:255]
  s_waitcnt lgkmcnt(2)
  v_mfma_f32_32x32x16_bf16 v[240:255], v[84:87], v[52:55], v[240:255]
  s_waitcnt lgkmcnt(1)
  v_mfma_f32_32x32x16_bf16 v[240:255], v[88:91], v[56:59], v[240:255]
  s_waitcnt lgkmcnt(0)
  v_mfma_f32_32x32x16_bf16 v[240:255], v[92:95], v[60:63], v[240:255]
  s_add_u32 s77, s82, 16384
  s_and_b32 s77, s77, 0xffff
  s_add_u32 s77, s77, s74
  s_add_u32 m0, s75, 8192
  s_nop 0
  buffer_load_dwordx4 v6, s[56:59], s77 offen offset:0 nt lds
  buffer_load_dwordx4 v7, s[56:59], s77 offen offset:1024 nt lds
  buffer_load_dwordx4 v8, s[56:59], s77 offen offset:2048 nt lds
  buffer_load_dwordx4 v9, s[56:59], s77 offen offset:3072 nt lds
  s_add_u32 m0, s75, 12288
  s_add_u32 s77, s77, 4096
  buffer_load_dwordx4 v6, s[56:59], s77 offen offset:0 nt lds
  buffer_load_dwordx4 v7, s[56:59], s77 offen offset:1024 nt lds
  buffer_load_dwordx4 v8, s[56:59], s77 offen offset:2048 nt lds
  buffer_load_dwordx4 v9, s[56:59], s77 offen offset:3072 nt lds
  s_nop 7
  v_max3_f32 v26, v26, v240, v241
  v_max3_f32 v26, v26, v242, v243
  v_max3_f32 v26, v26, v244, v245
  v_max3_f32 v26, v26, v246, v247
  v_max3_f32 v27, v27, v248, v249
  v_max3_f32 v27, v27, v250, v251
  v_max3_f32 v27, v27, v252, v253
  v_max3_f32 v27, v27, v254, v255
  v_max_f32 v26, v26, v27
  v_mov_b32 v27, v26
  s_nop 1
  v_permlane32_swap_b32 v26, v27
  s_nop 1
  v_max_f32 v32, v26, v27
  v_mul_f32 v33, s76, v32
  v_mov_b32 v34, 0
  v_mov_b32 v35, 0
  v_mov_b32 v36, 0
  v_mov_b32 v37, 0
  v_fma_f32 v40, v128, s76, -v33
  v_fma_f32 v41, v129, s76, -v33
  v_fma_f32 v42, v130, s76, -v33
  v_fma_f32 v43, v131, s76, -v33
  v_fma_f32 v44, v132, s76, -v33
  v_fma_f32 v45, v133, s76, -v33
  v_fma_f32 v46, v134, s76, -v33
  v_fma_f32 v47, v135, s76, -v33
  v_exp_f32 v40, v40
  v_exp_f32 v41, v41
  v_exp_f32 v42, v42
  v_exp_f32 v43, v43
  v_exp_f32 v44, v44
  v_exp_f32 v45, v45
  v_exp_f32 v46, v46
  v_exp_f32 v47, v47
  s_nop 0
  v_add_f32 v34, v34, v40
  v_add_f32 v35, v35, v41
  v_add_f32 v36, v36, v42
  v_add_f32 v37, v37, v43
  v_add_f32 v34, v34, v44
  v_add_f32 v35, v35, v45
  v_add_f32 v36, v36, v46
  v_add_f32 v37, v37, v47
  v_cvt_pk_bf16_f32 v48, v40, v41
  v_cvt_pk_bf16_f32 v49, v42, v43
  v_cvt_pk_bf16_f32 v50, v44, v45
  v_cvt_pk_bf16_f32 v51, v46, v47
  v_fma_f32 v40, v136, s76, -v33
  v_fma_f32 v41, v137, s76, -v33
  v_fma_f32 v42, v138, s76, -v33
  v_fma_f32 v43, v139, s76, -v33
  v_fma_f32 v44, v140, s76, -v33
  v_fma_f32 v45, v141, s76, -v33
  v_fma_f32 v46, v142, s76, -v33
  v_fma_f32 v47, v143, s76, -v33
  v_exp_f32 v40, v40
  v_exp_f32 v41, v41
  v_exp_f32 v42, v42
  v_exp_f32 v43, v43
  v_exp_f32 v44, v44
  v_exp_f32 v45, v45
  v_exp_f32 v46, v46
  v_exp_f32 v47, v47
  s_nop 0
  v_add_f32 v34, v34, v40
  v_add_f32 v35, v35, v41
  v_add_f32 v36, v36, v42
  v_add_f32 v37, v37, v43
  v_add_f32 v34, v34, v44
  v_add_f32 v35, v35, v45
  v_add_f32 v36, v36, v46
  v_add_f32 v37, v37, v47
  v_cvt_pk_bf16_f32 v52, v40, v41
  v_cvt_pk_bf16_f32 v53, v42, v43
  v_cvt_pk_bf16_f32 v54, v44, v45
  v_cvt_pk_bf16_f32 v55, v46, v47
  v_fma_f32 v40, v144, s76, -v33
  v_fma_f32 v41, v145, s76, -v33
  v_fma_f32 v42, v146, s76, -v33
  v_fma_f32 v43, v147, s76, -v33
  v_fma_f32 v44, v148, s76, -v33
  v_fma_f32 v45, v149, s76, -v33
  v_fma_f32 v46, v150, s76, -v33
  v_fma_f32 v47, v151, s76, -v33
  v_exp_f32 v40, v40
  v_exp_f32 v41, v41
  v_exp_f32 v42, v42
  v_exp_f32 v43, v43
  v_exp_f32 v44, v44
  v_exp_f32 v45, v45
  v_exp_f32 v46, v46
  v_exp_f32 v47, v47
  s_nop 0
  v_add_f32 v34, v34, v40
  v_add_f32 v35, v35, v41
  v_add_f32 v36, v36, v42
  v_add_f32 v37, v37, v43
  v_add_f32 v34, v34, v44
  v_add_f32 v35, v35, v45
  v_add_f32 v36, v36, v46
  v_add_f32 v37, v37, v47
  v_cvt_pk_bf16_f32 v56, v40, v41
  v_cvt_pk_bf16_f32 v57, v42, v43
  v_cvt_pk_bf16_f32 v58, v44, v45
  v_cvt_pk_bf16_f32 v59, v46, v47
  v_fma_f32 v40, v152, s76, -v33
  v_fma_f32 v41, v153, s76, -v33
  v_fma_f32 v42, v154, s76, -v33
  v_fma_f32 v43, v155, s76, -v33
  v_fma_f32 v44, v156, s76, -v33
  v_fma_f32 v45, v157, s76, -v33
  v_fma_f32 v46, v158, s76, -v33
  v_fma_f32 v47, v159, s76, -v33
  v_exp_f32 v40, v40
  v_exp_f32 v41, v41
  v_exp_f32 v42, v42
  v_exp_f32 v43, v43
  v_exp_f32 v44, v44
  v_exp_f32 v45, v45
  v_exp_f32 v46, v46
  v_exp_f32 v47, v47
  s_nop 0
  v_add_f32 v34, v34, v40
  v_add_f32 v35, v35, v41
  v_add_f32 v36, v36, v42
  v_add_f32 v37, v37, v43
  v_add_f32 v34, v34, v44
  v_add_f32 v35, v35, v45
  v_add_f32 v36, v36, v46
  v_add_f32 v37, v37, v47
  v_cvt_pk_bf16_f32 v60, v40, v41
  v_cvt_pk_bf16_f32 v61, v42, v43
  v_cvt_pk_bf16_f32 v62, v44, v45
  v_cvt_pk_bf16_f32 v63, v46, v47
  s_waitcnt vmcnt(16)
  s_barrier
  ds_read_b64_tr_b16 v[64:65], v18 offset:16384
  ds_read_b64_tr_b16 v[66:67], v19 offset:16384
  ds_read_b64_tr_b16 v[68:69], v20 offset:16384
  ds_read_b64_tr_b16 v[70:71], v21 offset:16384
  ds_read_b64_tr_b16 v[72:73], v22 offset:16384
  ds_read_b64_tr_b16 v[74:75], v23 offset:16384
  ds_read_b64_tr_b16 v[76:77], v24 offset:16384
  ds_read_b64_tr_b16 v[78:79], v25 offset:16384
  ds_read_b64_tr_b16 v[80:81], v18 offset:20480
  ds_read_b64_tr_b16 v[82:83], v19 offset:20480
  ds_read_b64_tr_b16 v[84:85], v20 offset:20480
  ds_read_b64_tr_b16 v[86:87], v21 offset:20480
  ds_read_b64_tr_b16 v[88:89], v22 offset:20480
  ds_read_b64_tr_b16 v[90:91], v23 offset:20480
  ds_read_b64_tr_b16 v[92:93], v24 offset:20480
  ds_read_b64_tr_b16 v[94:95], v25 offset:20480
  s_waitcnt lgkmcnt(14)
  v_mfma_f32_32x32x16_bf16 v[128:143], v[64:67], v[48:51], 0
  s_waitcnt lgkmcnt(12)
  v_mfma_f32_32x32x16_bf16 v[144:159], v[68:71], v[48:51], 0
  s_waitcnt lgkmcnt(10)
  v_mfma_f32_32x32x16_bf16 v[96:111], v[72:75], v[48:51], 0
  s_waitcnt lgkmcnt(8)
  v_mfma_f32_32x32x16_bf16 v[112:127], v[76:79], v[48:51], 0
  s_waitcnt lgkmcnt(6)
  v_mfma_f32_32x32x16_bf16 v[128:143], v[80:83], v[52:55], v[128:143]
  s_waitcnt lgkmcnt(4)
  v_mfma_f32_32x32x16_bf16 v[144:159], v[84:87], v[52:55], v[144:159]
  s_waitcnt lgkmcnt(2)
  v_mfma_f32_32x32x16_bf16 v[96:111], v[88:91], v[52:55], v[96:111]
  s_waitcnt lgkmcnt(0)
  v_mfma_f32_32x32x16_bf16 v[112:127], v[92:95], v[52:55], v[112:127]
  s_add_u32 s77, s82, 24576
  s_and_b32 s77, s77, 0xffff
  s_add_u32 s77, s77, s74
  s_add_u32 m0, s75, 16384
  s_nop 0
  buffer_load_dwordx4 v6, s[56:59], s77 offen offset:0 nt lds
  buffer_load_dwordx4 v7, s[56:59], s77 offen offset:1024 nt lds
  buffer_load_dwordx4 v8, s[56:59], s77 offen offset:2048 nt lds
  buffer_load_dwordx4 v9, s[56:59], s77 offen offset:3072 nt lds
  s_add_u32 m0, s75, 20480
  s_add_u32 s77, s77, 4096
  buffer_load_dwordx4 v6, s[56:59], s77 offen offset:0 nt lds
  buffer_load_dwordx4 v7, s[56:59], s77 offen offset:1024 nt lds
  buffer_load_dwordx4 v8, s[56:59], s77 offen offset:2048 nt lds
  buffer_load_dwordx4 v9, s[56:59], s77 offen offset:3072 nt lds
  v_fma_f32 v40, v160, s76, -v33
  v_fma_f32 v41, v161, s76, -v33
  v_fma_f32 v42, v162, s76, -v33
  v_fma_f32 v43, v163, s76, -v33
  v_fma_f32 v44, v164, s76, -v33
  v_fma_f32 v45, v165, s76, -v33
  v_fma_f32 v46, v166, s76, -v33
  v_fma_f32 v47, v167, s76, -v33
  v_exp_f32 v40, v40
  v_exp_f32 v41, v41
  v_exp_f32 v42, v42
  v_exp_f32 v43, v43
  v_exp_f32 v44, v44
  v_exp_f32 v45, v45
  v_exp_f32 v46, v46
  v_exp_f32 v47, v47
  s_nop 0
  v_add_f32 v34, v34, v40
  v_add_f32 v35, v35, v41
  v_add_f32 v36, v36, v42
  v_add_f32 v37, v37, v43
  v_add_f32 v34, v34, v44
  v_add_f32 v35, v35, v45
  v_add_f32 v36, v36, v46
  v_add_f32 v37, v37, v47
  v_cvt_pk_bf16_f32 v48, v40, v41
  v_cvt_pk_bf16_f32 v49, v42, v43
  v_cvt_pk_bf16_f32 v50, v44, v45
  v_cvt_pk_bf16_f32 v51, v46, v47
  v_fma_f32 v40, v168, s76, -v33
  v_fma_f32 v41, v169, s76, -v33
  v_fma_f32 v42, v170, s76, -v33
  v_fma_f32 v43, v171, s76, -v33
  v_fma_f32 v44, v172, s76, -v33
  v_fma_f32 v45, v173, s76, -v33
  v_fma_f32 v46, v174, s76, -v33
  v_fma_f32 v47, v175, s76, -v33
  v_exp_f32 v40, v40
  v_exp_f32 v41, v41
  v_exp_f32 v42, v42
  v_exp_f32 v43, v43
  v_exp_f32 v44, v44
  v_exp_f32 v45, v45
  v_exp_f32 v46, v46
  v_exp_f32 v47, v47
  s_nop 0
  v_add_f32 v34, v34, v40
  v_add_f32 v35, v35, v41
  v_add_f32 v36, v36, v42
  v_add_f32 v37, v37, v43
  v_add_f32 v34, v34, v44
  v_add_f32 v35, v35, v45
  v_add_f32 v36, v36, v46
  v_add_f32 v37, v37, v47
  v_cvt_pk_bf16_f32 v52, v40, v41
  v_cvt_pk_bf16_f32 v53, v42, v43
  v_cvt_pk_bf16_f32 v54, v44, v45
  v_cvt_pk_bf16_f32 v55, v46, v47
  s_waitcnt vmcnt(16)
  s_barrier
  ds_read_b64_tr_b16 v[64:65], v18 offset:0
  ds_read_b64_tr_b16 v[66:67], v19 offset:0
  ds_read_b64_tr_b16 v[68:69], v20 offset:0
  ds_read_b64_tr_b16 v[70:71], v21 offset:0
  ds_read_b64_tr_b16 v[72:73], v22 offset:0
  ds_read_b64_tr_b16 v[74:75], v23 offset:0
  ds_read_b64_tr_b16 v[76:77], v24 offset:0
  ds_read_b64_tr_b16 v[78:79], v25 offset:0
  ds_read_b64_tr_b16 v[80:81], v18 offset:4096
  ds_read_b64_tr_b16 v[82:83], v19 offset:4096
  ds_read_b64_tr_b16 v[84:85], v20 offset:4096
  ds_read_b64_tr_b16 v[86:87], v21 offset:4096
  ds_read_b64_tr_b16 v[88:89], v22 offset:4096
  ds_read_b64_tr_b16 v[90:91], v23 offset:4096
  ds_read_b64_tr_b16 v[92:93], v24 offset:4096
  ds_read_b64_tr_b16 v[94:95], v25 offset:4096
  s_waitcnt lgkmcnt(14)
  v_mfma_f32_32x32x16_bf16 v[128:143], v[64:67], v[56:59], v[128:143]
  s_waitcnt lgkmcnt(12)
  v_mfma_f32_32x32x16_bf16 v[144:159], v[68:71], v[56:59], v[144:159]
  s_waitcnt lgkmcnt(10)
  v_mfma_f32_32x32x16_bf16 v[96:111], v[72:75], v[56:59], v[96:111]
  s_waitcnt lgkmcnt(8)
  v_mfma_f32_32x32x16_bf16 v[112:127], v[76:79], v[56:59], v[112:127]
  s_waitcnt lgkmcnt(6)
  v_mfma_f32_32x32x16_bf16 v[128:143], v[80:83], v[60:63], v[128:143]
  s_waitcnt lgkmcnt(4)
  v_mfma_f32_32x32x16_bf16 v[144:159], v[84:87], v[60:63], v[144:159]
  s_waitcnt lgkmcnt(2)
  v_mfma_f32_32x32x16_bf16 v[96:111], v[88:91], v[60:63], v[96:111]
  s_waitcnt lgkmcnt(0)
  v_mfma_f32_32x32x16_bf16 v[112:127], v[92:95], v[60:63], v[112:127]
  s_add_u32 s77, s82, 32768
  s_and_b32 s77, s77, 0xffff
  s_add_u32 s77, s77, s74
  s_add_u32 m0, s75, 0
  s_nop 0
  buffer_load_dwordx4 v6, s[56:59], s77 offen offset:0 nt lds
  buffer_load_dwordx4 v7, s[56:59], s77 offen offset:1024 nt lds
  buffer_load_dwordx4 v8, s[56:59], s77 offen offset:2048 nt lds
  buffer_load_dwordx4 v9, s[56:59], s77 offen offset:3072 nt lds
  s_add_u32 m0, s75, 4096
  s_add_u32 s77, s77, 4096
  buffer_load_dwordx4 v6, s[56:59], s77 offen offset:0 nt lds
  buffer_load_dwordx4 v7, s[56:59], s77 offen offset:1024 nt lds
  buffer_load_dwordx4 v8, s[56:59], s77 offen offset:2048 nt lds
  buffer_load_dwordx4 v9, s[56:59], s77 offen offset:3072 nt lds
  v_fma_f32 v40, v176, s76, -v33
  v_fma_f32 v41, v177, s76, -v33
  v_fma_f32 v42, v178, s76, -v33
  v_fma_f32 v43, v179, s76, -v33
  v_fma_f32 v44, v180, s76, -v33
  v_fma_f32 v45, v181, s76, -v33
  v_fma_f32 v46, v182, s76, -v33
  v_fma_f32 v47, v183, s76, -v33
  v_exp_f32 v40, v40
  v_exp_f32 v41, v41
  v_exp_f32 v42, v42
  v_exp_f32 v43, v43
  v_exp_f32 v44, v44
  v_exp_f32 v45, v45
  v_exp_f32 v46, v46
  v_exp_f32 v47, v47
  s_nop 0
  v_add_f32 v34, v34, v40
  v_add_f32 v35, v35, v41
  v_add_f32 v36, v36, v42
  v_add_f32 v37, v37, v43
  v_add_f32 v34, v34, v44
  v_add_f32 v35, v35, v45
  v_add_f32 v36, v36, v46
  v_add_f32 v37, v37, v47
  v_cvt_pk_bf16_f32 v56, v40, v41
  v_cvt_pk_bf16_f32 v57, v42, v43
  v_cvt_pk_bf16_f32 v58, v44, v45
  v_cvt_pk_bf16_f32 v59, v46, v47
  v_fma_f32 v40, v184, s76, -v33
  v_fma_f32 v41, v185, s76, -v33
  v_fma_f32 v42, v186, s76, -v33
  v_fma_f32 v43, v187, s76, -v33
  v_fma_f32 v44, v188, s76, -v33
  v_fma_f32 v45, v189, s76, -v33
  v_fma_f32 v46, v190, s76, -v33
  v_fma_f32 v47, v191, s76, -v33
  v_exp_f32 v40, v40
  v_exp_f32 v41, v41
  v_exp_f32 v42, v42
  v_exp_f32 v43, v43
  v_exp_f32 v44, v44
  v_exp_f32 v45, v45
  v_exp_f32 v46, v46
  v_exp_f32 v47, v47
  s_nop 0
  v_add_f32 v34, v34, v40
  v_add_f32 v35, v35, v41
  v_add_f32 v36, v36, v42
  v_add_f32 v37, v37, v43
  v_add_f32 v34, v34, v44
  v_add_f32 v35, v35, v45
  v_add_f32 v36, v36, v46
  v_add_f32 v37, v37, v47
  v_cvt_pk_bf16_f32 v60, v40, v41
  v_cvt_pk_bf16_f32 v61, v42, v43
  v_cvt_pk_bf16_f32 v62, v44, v45
  v_cvt_pk_bf16_f32 v63, v46, v47
  s_waitcnt vmcnt(16)
  s_barrier
  ds_read_b64_tr_b16 v[64:65], v18 offset:8192
  ds_read_b64_tr_b16 v[66:67], v19 offset:8192
  ds_read_b64_tr_b16 v[68:69], v20 offset:8192
  ds_read_b64_tr_b16 v[70:71], v21 offset:8192
  ds_read_b64_tr_b16 v[72:73], v22 offset:8192
  ds_read_b64_tr_b16 v[74:75], v23 offset:8192
  ds_read_b64_tr_b16 v[76:77], v24 offset:8192
  ds_read_b64_tr_b16 v[78:79], v25 offset:8192
  ds_read_b64_tr_b16 v[80:81], v18 offset:12288
  ds_read_b64_tr_b16 v[82:83], v19 offset:12288
  ds_read_b64_tr_b16 v[84:85], v20 offset:12288
  ds_read_b64_tr_b16 v[86:87], v21 offset:12288
  ds_read_b64_tr_b16 v[88:89], v22 offset:12288
  ds_read_b64_tr_b16 v[90:91], v23 offset:12288
  ds_read_b64_tr_b16 v[92:93], v24 offset:12288
  ds_read_b64_tr_b16 v[94:95], v25 offset:12288
  s_waitcnt lgkmcnt(14)
  v_mfma_f32_32x32x16_bf16 v[128:143], v[64:67], v[48:51], v[128:143]
  s_waitcnt lgkmcnt(12)
  v_mfma_f32_32x32x16_bf16 v[144:159], v[68:71], v[48:51], v[144:159]
  s_waitcnt lgkmcnt(10)
  v_mfma_f32_32x32x16_bf16 v[96:111], v[72:75], v[48:51], v[96:111]
  s_waitcnt lgkmcnt(8)
  v_mfma_f32_32x32x16_bf16 v[112:127], v[76:79], v[48:51], v[112:127]
  s_waitcnt lgkmcnt(6)
  v_mfma_f32_32x32x16_bf16 v[128:143], v[80:83], v[52:55], v[128:143]
  s_waitcnt lgkmcnt(4)
  v_mfma_f32_32x32x16_bf16 v[144:159], v[84:87], v[52:55], v[144:159]
  s_waitcnt lgkmcnt(2)
  v_mfma_f32_32x32x16_bf16 v[96:111], v[88:91], v[52:55], v[96:111]
  s_waitcnt lgkmcnt(0)
  v_mfma_f32_32x32x16_bf16 v[112:127], v[92:95], v[52:55], v[112:127]
  s_add_u32 s77, s82, 40960
  s_and_b32 s77, s77, 0xffff
  s_add_u32 s77, s77, s74
  s_add_u32 m0, s75, 8192
  s_nop 0
  buffer_load_dwordx4 v6, s[56:59], s77 offen offset:0 nt lds
  buffer_load_dwordx4 v7, s[56:59], s77 offen offset:1024 nt lds
  buffer_load_dwordx4 v8, s[56:59], s77 offen offset:2048 nt lds
  buffer_load_dwordx4 v9, s[56:59], s77 offen offset:3072 nt lds
  s_add_u32 m0, s75, 12288
  s_add_u32 s77, s77, 4096
  buffer_load_dwordx4 v6, s[56:59], s77 offen offset:0 nt lds
  buffer_load_dwordx4 v7, s[56:59], s77 offen offset:1024 nt lds
  buffer_load_dwordx4 v8, s[56:59], s77 offen offset:2048 nt lds
  buffer_load_dwordx4 v9, s[56:59], s77 offen offset:3072 nt lds
  v_fma_f32 v40, v192, s76, -v33
  v_fma_f32 v41, v193, s76, -v33
  v_fma_f32 v42, v194, s76, -v33
  v_fma_f32 v43, v195, s76, -v33
  v_fma_f32 v44, v196, s76, -v33
  v_fma_f32 v45, v197, s76, -v33
  v_fma_f32 v46, v198, s76, -v33
  v_fma_f32 v47, v199, s76, -v33
  v_exp_f32 v40, v40
  v_exp_f32 v41, v41
  v_exp_f32 v42, v42
  v_exp_f32 v43, v43
  v_exp_f32 v44, v44
  v_exp_f32 v45, v45
  v_exp_f32 v46, v46
  v_exp_f32 v47, v47
  s_nop 0
  v_add_f32 v34, v34, v40
  v_add_f32 v35, v35, v41
  v_add_f32 v36, v36, v42
  v_add_f32 v37, v37, v43
  v_add_f32 v34, v34, v44
  v_add_f32 v35, v35, v45
  v_add_f32 v36, v36, v46
  v_add_f32 v37, v37, v47
  v_cvt_pk_bf16_f32 v48, v40, v41
  v_cvt_pk_bf16_f32 v49, v42, v43
  v_cvt_pk_bf16_f32 v50, v44, v45
  v_cvt_pk_bf16_f32 v51, v46, v47
  v_fma_f32 v40, v200, s76, -v33
  v_fma_f32 v41, v201, s76, -v33
  v_fma_f32 v42, v202, s76, -v33
  v_fma_f32 v43, v203, s76, -v33
  v_fma_f32 v44, v204, s76, -v33
  v_fma_f32 v45, v205, s76, -v33
  v_fma_f32 v46, v206, s76, -v33
  v_fma_f32 v47, v207, s76, -v33
  v_exp_f32 v40, v40
  v_exp_f32 v41, v41
  v_exp_f32 v42, v42
  v_exp_f32 v43, v43
  v_exp_f32 v44, v44
  v_exp_f32 v45, v45
  v_exp_f32 v46, v46
  v_exp_f32 v47, v47
  s_nop 0
  v_add_f32 v34, v34, v40
  v_add_f32 v35, v35, v41
  v_add_f32 v36, v36, v42
  v_add_f32 v37, v37, v43
  v_add_f32 v34, v34, v44
  v_add_f32 v35, v35, v45
  v_add_f32 v36, v36, v46
  v_add_f32 v37, v37, v47
  v_cvt_pk_bf16_f32 v52, v40, v41
  v_cvt_pk_bf16_f32 v53, v42, v43
  v_cvt_pk_bf16_f32 v54, v44, v45
  v_cvt_pk_bf16_f32 v55, v46, v47
  s_waitcnt vmcnt(16)
  s_barrier
  ds_read_b64_tr_b16 v[64:65], v18 offset:16384
  ds_read_b64_tr_b16 v[66:67], v19 offset:16384
  ds_read_b64_tr_b16 v[68:69], v20 offset:16384
  ds_read_b64_tr_b16 v[70:71], v21 offset:16384
  ds_read_b64_tr_b16 v[72:73], v22 offset:16384
  ds_read_b64_tr_b16 v[74:75], v23 offset:16384
  ds_read_b64_tr_b16 v[76:77], v24 offset:16384
  ds_read_b64_tr_b16 v[78:79], v25 offset:16384
  ds_read_b64_tr_b16 v[80:81], v18 offset:20480
  ds_read_b64_tr_b16 v[82:83], v19 offset:20480
  ds_read_b64_tr_b16 v[84:85], v20 offset:20480
  ds_read_b64_tr_b16 v[86:87], v21 offset:20480
  ds_read_b64_tr_b16 v[88:89], v22 offset:20480
  ds_read_b64_tr_b16 v[90:91], v23 offset:20480
  ds_read_b64_tr_b16 v[92:93], v24 offset:20480
  ds_read_b64_tr_b16 v[94:95], v25 offset:20480
  s_waitcnt lgkmcnt(14)
  v_mfma_f32_32x32x16_bf16 v[128:143], v[64:67], v[56:59], v[128:143]
  s_waitcnt lgkmcnt(12)
  v_mfma_f32_32x32x16_bf16 v[144:159], v[68:71], v[56:59], v[144:159]
  s_waitcnt lgkmcnt(10)
  v_mfma_f32_32x32x16_bf16 v[96:111], v[72:75], v[56:59], v[96:111]
  s_waitcnt lgkmcnt(8)
  v_mfma_f32_32x32x16_bf16 v[112:127], v[76:79], v[56:59], v[112:127]
  s_waitcnt lgkmcnt(6)
  v_mfma_f32_32x32x16_bf16 v[128:143], v[80:83], v[60:63], v[128:143]
  s_waitcnt lgkmcnt(4)
  v_mfma_f32_32x32x16_bf16 v[144:159], v[84:87], v[60:63], v[144:159]
  s_waitcnt lgkmcnt(2)
  v_mfma_f32_32x32x16_bf16 v[96:111], v[88:91], v[60:63], v[96:111]
  s_waitcnt lgkmcnt(0)
  v_mfma_f32_32x32x16_bf16 v[112:127], v[92:95], v[60:63], v[112:127]
  s_add_u32 s77, s82, 49152
  s_and_b32 s77, s77, 0xffff
  s_add_u32 s77, s77, s74
  s_add_u32 m0, s75, 16384
  s_nop 0
  buffer_load_dwordx4 v6, s[56:59], s77 offen offset:0 nt lds
  buffer_load_dwordx4 v7, s[56:59], s77 offen offset:1024 nt lds
  buffer_load_dwordx4 v8, s[56:59], s77 offen offset:2048 nt lds
  buffer_load_dwordx4 v9, s[56:59], s77 offen offset:3072 nt lds
  s_add_u32 m0, s75, 20480
  s_add_u32 s77, s77, 4096
  buffer_load_dwordx4 v6, s[56:59], s77 offen offset:0 nt lds
  buffer_load_dwordx4 v7, s[56:59], s77 offen offset:1024 nt lds
  buffer_load_dwordx4 v8, s[56:59], s77 offen offset:2048 nt lds
  buffer_load_dwordx4 v9, s[56:59], s77 offen offset:3072 nt lds
  v_fma_f32 v40, v208, s76, -v33
  v_fma_f32 v41, v209, s76, -v33
  v_fma_f32 v42, v210, s76, -v33
  v_fma_f32 v43, v211, s76, -v33
  v_fma_f32 v44, v212, s76, -v33
  v_fma_f32 v45, v213, s76, -v33
  v_fma_f32 v46, v214, s76, -v33
  v_fma_f32 v47, v215, s76, -v33
  v_exp_f32 v40, v40
  v_exp_f32 v41, v41
  v_exp_f32 v42, v42
  v_exp_f32 v43, v43
  v_exp_f32 v44, v44
  v_exp_f32 v45, v45
  v_exp_f32 v46, v46
  v_exp_f32 v47, v47
  s_nop 0
  v_add_f32 v34, v34, v40
  v_add_f32 v35, v35, v41
  v_add_f32 v36, v36, v42
  v_add_f32 v37, v37, v43
  v_add_f32 v34, v34, v44
  v_add_f32 v35, v35, v45
  v_add_f32 v36, v36, v46
  v_add_f32 v37, v37, v47
  v_cvt_pk_bf16_f32 v56, v40, v41
  v_cvt_pk_bf16_f32 v57, v42, v43
  v_cvt_pk_bf16_f32 v58, v44, v45
  v_cvt_pk_bf16_f32 v59, v46, v47
  v_fma_f32 v40, v216, s76, -v33
  v_fma_f32 v41, v217, s76, -v33
  v_fma_f32 v42, v218, s76, -v33
  v_fma_f32 v43, v219, s76, -v33
  v_fma_f32 v44, v220, s76, -v33
  v_fma_f32 v45, v221, s76, -v33
  v_fma_f32 v46, v222, s76, -v33
  v_fma_f32 v47, v223, s76, -v33
  v_exp_f32 v40, v40
  v_exp_f32 v41, v41
  v_exp_f32 v42, v42
  v_exp_f32 v43, v43
  v_exp_f32 v44, v44
  v_exp_f32 v45, v45
  v_exp_f32 v46, v46
  v_exp_f32 v47, v47
  s_nop 0
  v_add_f32 v34, v34, v40
  v_add_f32 v35, v35, v41
  v_add_f32 v36, v36, v42
  v_add_f32 v37, v37, v43
  v_add_f32 v34, v34, v44
  v_add_f32 v35, v35, v45
  v_add_f32 v36, v36, v46
  v_add_f32 v37, v37, v47
  v_cvt_pk_bf16_f32 v60, v40, v41
  v_cvt_pk_bf16_f32 v61, v42, v43
  v_cvt_pk_bf16_f32 v62, v44, v45
  v_cvt_pk_bf16_f32 v63, v46, v47
  s_waitcnt vmcnt(16)
  s_barrier
  ds_read_b64_tr_b16 v[64:65], v18 offset:0
  ds_read_b64_tr_b16 v[66:67], v19 offset:0
  ds_read_b64_tr_b16 v[68:69], v20 offset:0
  ds_read_b64_tr_b16 v[70:71], v21 offset:0
  ds_read_b64_tr_b16 v[72:73], v22 offset:0
  ds_read_b64_tr_b16 v[74:75], v23 offset:0
  ds_read_b64_tr_b16 v[76:77], v24 offset:0
  ds_read_b64_tr_b16 v[78:79], v25 offset:0
  ds_read_b64_tr_b16 v[80:81], v18 offset:4096
  ds_read_b64_tr_b16 v[82:83], v19 offset:4096
  ds_read_b64_tr_b16 v[84:85], v20 offset:4096
  ds_read_b64_tr_b16 v[86:87], v21 offset:4096
  ds_read_b64_tr_b16 v[88:89], v22 offset:4096
  ds_read_b64_tr_b16 v[90:91], v23 offset:4096
  ds_read_b64_tr_b16 v[92:93], v24 offset:4096
  ds_read_b64_tr_b16 v[94:95], v25 offset:4096
  s_waitcnt lgkmcnt(14)
  v_mfma_f32_32x32x16_bf16 v[128:143], v[64:67], v[48:51], v[128:143]
  s_waitcnt lgkmcnt(12)
  v_mfma_f32_32x32x16_bf16 v[144:159], v[68:71], v[48:51], v[144:159]
  s_waitcnt lgkmcnt(10)
  v_mfma_f32_32x32x16_bf16 v[96:111], v[72:75], v[48:51], v[96:111]
  s_waitcnt lgkmcnt(8)
  v_mfma_f32_32x32x16_bf16 v[112:127], v[76:79], v[48:51], v[112:127]
  s_waitcnt lgkmcnt(6)
  v_mfma_f32_32x32x16_bf16 v[128:143], v[80:83], v[52:55], v[128:143]
  s_waitcnt lgkmcnt(4)
  v_mfma_f32_32x32x16_bf16 v[144:159], v[84:87], v[52:55], v[144:159]
  s_waitcnt lgkmcnt(2)
  v_mfma_f32_32x32x16_bf16 v[96:111], v[88:91], v[52:55], v[96:111]
  s_waitcnt lgkmcnt(0)
  v_mfma_f32_32x32x16_bf16 v[112:127], v[92:95], v[52:55], v[112:127]
  s_add_u32 s77, s82, 57344
  s_and_b32 s77, s77, 0xffff
  s_add_u32 s77, s77, s74
  s_add_u32 m0, s75, 0
  s_nop 0
  buffer_load_dwordx4 v6, s[56:59], s77 offen offset:0 nt lds
  buffer_load_dwordx4 v7, s[56:59], s77 offen offset:1024 nt lds
  buffer_load_dwordx4 v8, s[56:59], s77 offen offset:2048 nt lds
  buffer_load_dwordx4 v9, s[56:59], s77 offen offset:3072 nt lds
  s_add_u32 m0, s75, 4096
  s_add_u32 s77, s77, 4096
  buffer_load_dwordx4 v6, s[56:59], s77 offen offset:0 nt lds
  buffer_load_dwordx4 v7, s[56:59], s77 offen offset:1024 nt lds
  buffer_load_dwordx4 v8, s[56:59], s77 offen offset:2048 nt lds
  buffer_load_dwordx4 v9, s[56:59], s77 offen offset:3072 nt lds
  v_fma_f32 v40, v224, s76, -v33
  v_fma_f32 v41, v225, s76, -v33
  v_fma_f32 v42, v226, s76, -v33
  v_fma_f32 v43, v227, s76, -v33
  v_fma_f32 v44, v228, s76, -v33
  v_fma_f32 v45, v229, s76, -v33
  v_fma_f32 v46, v230, s76, -v33
  v_fma_f32 v47, v231, s76, -v33
  v_exp_f32 v40, v40
  v_exp_f32 v41, v41
  v_exp_f32 v42, v42
  v_exp_f32 v43, v43
  v_exp_f32 v44, v44
  v_exp_f32 v45, v45
  v_exp_f32 v46, v46
  v_exp_f32 v47, v47
  s_nop 0
  v_add_f32 v34, v34, v40
  v_add_f32 v35, v35, v41
  v_add_f32 v36, v36, v42
  v_add_f32 v37, v37, v43
  v_add_f32 v34, v34, v44
  v_add_f32 v35, v35, v45
  v_add_f32 v36, v36, v46
  v_add_f32 v37, v37, v47
  v_cvt_pk_bf16_f32 v48, v40, v41
  v_cvt_pk_bf16_f32 v49, v42, v43
  v_cvt_pk_bf16_f32 v50, v44, v45
  v_cvt_pk_bf16_f32 v51, v46, v47
  v_fma_f32 v40, v232, s76, -v33
  v_fma_f32 v41, v233, s76, -v33
  v_fma_f32 v42, v234, s76, -v33
  v_fma_f32 v43, v235, s76, -v33
  v_fma_f32 v44, v236, s76, -v33
  v_fma_f32 v45, v237, s76, -v33
  v_fma_f32 v46, v238, s76, -v33
  v_fma_f32 v47, v239, s76, -v33
  v_exp_f32 v40, v40
  v_exp_f32 v41, v41
  v_exp_f32 v42, v42
  v_exp_f32 v43, v43
  v_exp_f32 v44, v44
  v_exp_f32 v45, v45
  v_exp_f32 v46, v46
  v_exp_f32 v47, v47
  s_nop 0
  v_add_f32 v34, v34, v40
  v_add_f32 v35, v35, v41
  v_add_f32 v36, v36, v42
  v_add_f32 v37, v37, v43
  v_add_f32 v34, v34, v44
  v_add_f32 v35, v35, v45
  v_add_f32 v36, v36, v46
  v_add_f32 v37, v37, v47
  v_cvt_pk_bf16_f32 v52, v40, v41
  v_cvt_pk_bf16_f32 v53, v42, v43
  v_cvt_pk_bf16_f32 v54, v44, v45
  v_cvt_pk_bf16_f32 v55, v46, v47
  s_waitcnt vmcnt(16)
  s_barrier
  ds_read_b64_tr_b16 v[64:65], v18 offset:8192
  ds_read_b64_tr_b16 v[66:67], v19 offset:8192
  ds_read_b64_tr_b16 v[68:69], v20 offset:8192
  ds_read_b64_tr_b16 v[70:71], v21 offset:8192
  ds_read_b64_tr_b16 v[72:73], v22 offset:8192
  ds_read_b64_tr_b16 v[74:75], v23 offset:8192
  ds_read_b64_tr_b16 v[76:77], v24 offset:8192
  ds_read_b64_tr_b16 v[78:79], v25 offset:8192
  ds_read_b64_tr_b16 v[80:81], v18 offset:12288
  ds_read_b64_tr_b16 v[82:83], v19 offset:12288
  ds_read_b64_tr_b16 v[84:85], v20 offset:12288
  ds_read_b64_tr_b16 v[86:87], v21 offset:12288
  ds_read_b64_tr_b16 v[88:89], v22 offset:12288
  ds_read_b64_tr_b16 v[90:91], v23 offset:12288
  ds_read_b64_tr_b16 v[92:93], v24 offset:12288
  ds_read_b64_tr_b16 v[94:95], v25 offset:12288
  s_waitcnt lgkmcnt(14)
  v_mfma_f32_32x32x16_bf16 v[128:143], v[64:67], v[56:59], v[128:143]
  s_waitcnt lgkmcnt(12)
  v_mfma_f32_32x32x16_bf16 v[144:159], v[68:71], v[56:59], v[144:159]
  s_waitcnt lgkmcnt(10)
  v_mfma_f32_32x32x16_bf16 v[96:111], v[72:75], v[56:59], v[96:111]
  s_waitcnt lgkmcnt(8)
  v_mfma_f32_32x32x16_bf16 v[112:127], v[76:79], v[56:59], v[112:127]
  s_waitcnt lgkmcnt(6)
  v_mfma_f32_32x32x16_bf16 v[128:143], v[80:83], v[60:63], v[128:143]
  s_waitcnt lgkmcnt(4)
  v_mfma_f32_32x32x16_bf16 v[144:159], v[84:87], v[60:63], v[144:159]
  s_waitcnt lgkmcnt(2)
  v_mfma_f32_32x32x16_bf16 v[96:111], v[88:91], v[60:63], v[96:111]
  s_waitcnt lgkmcnt(0)
  v_mfma_f32_32x32x16_bf16 v[112:127], v[92:95], v[60:63], v[112:127]
  v_fma_f32 v40, v240, s76, -v33
  v_fma_f32 v41, v241, s76, -v33
  v_fma_f32 v42, v242, s76, -v33
  v_fma_f32 v43, v243, s76, -v33
  v_fma_f32 v44, v244, s76, -v33
  v_fma_f32 v45, v245, s76, -v33
  v_fma_f32 v46, v246, s76, -v33
  v_fma_f32 v47, v247, s76, -v33
  v_exp_f32 v40, v40
  v_exp_f32 v41, v41
  v_exp_f32 v42, v42
  v_exp_f32 v43, v43
  v_exp_f32 v44, v44
  v_exp_f32 v45, v45
  v_exp_f32 v46, v46
  v_exp_f32 v47, v47
  s_nop 0
  v_add_f32 v34, v34, v40
  v_add_f32 v35, v35, v41
  v_add_f32 v36, v36, v42
  v_add_f32 v37, v37, v43
  v_add_f32 v34, v34, v44
  v_add_f32 v35, v35, v45
  v_add_f32 v36, v36, v46
  v_add_f32 v37, v37, v47
  v_cvt_pk_bf16_f32 v56, v40, v41
  v_cvt_pk_bf16_f32 v57, v42, v43
  v_cvt_pk_bf16_f32 v58, v44, v45
  v_cvt_pk_bf16_f32 v59, v46, v47
  v_fma_f32 v40, v248, s76, -v33
  v_fma_f32 v41, v249, s76, -v33
  v_fma_f32 v42, v250, s76, -v33
  v_fma_f32 v43, v251, s76, -v33
  v_fma_f32 v44, v252, s76, -v33
  v_fma_f32 v45, v253, s76, -v33
  v_fma_f32 v46, v254, s76, -v33
  v_fma_f32 v47, v255, s76, -v33
  v_exp_f32 v40, v40
  v_exp_f32 v41, v41
  v_exp_f32 v42, v42
  v_exp_f32 v43, v43
  v_exp_f32 v44, v44
  v_exp_f32 v45, v45
  v_exp_f32 v46, v46
  v_exp_f32 v47, v47
  s_nop 0
  v_add_f32 v34, v34, v40
  v_add_f32 v35, v35, v41
  v_add_f32 v36, v36, v42
  v_add_f32 v37, v37, v43
  v_add_f32 v34, v34, v44
  v_add_f32 v35, v35, v45
  v_add_f32 v36, v36, v46
  v_add_f32 v37, v37, v47
  v_cvt_pk_bf16_f32 v60, v40, v41
  v_cvt_pk_bf16_f32 v61, v42, v43
  v_cvt_pk_bf16_f32 v62, v44, v45
  v_cvt_pk_bf16_f32 v63, v46, v47
  s_waitcnt vmcnt(8)
  s_barrier
  ds_read_b64_tr_b16 v[64:65], v18 offset:16384
  ds_read_b64_tr_b16 v[66:67], v19 offset:16384
  ds_read_b64_tr_b16 v[68:69], v20 offset:16384
  ds_read_b64_tr_b16 v[70:71], v21 offset:16384
  ds_read_b64_tr_b16 v[72:73], v22 offset:16384
  ds_read_b64_tr_b16 v[74:75], v23 offset:16384
  ds_read_b64_tr_b16 v[76:77], v24 offset:16384
  ds_read_b64_tr_b16 v[78:79], v25 offset:16384
  ds_read_b64_tr_b16 v[80:81], v18 offset:20480
  ds_read_b64_tr_b16 v[82:83], v19 offset:20480
  ds_read_b64_tr_b16 v[84:85], v20 offset:20480
  ds_read_b64_tr_b16 v[86:87], v21 offset:20480
  ds_read_b64_tr_b16 v[88:89], v22 offset:20480
  ds_read_b64_tr_b16 v[90:91], v23 offset:20480
  ds_read_b64_tr_b16 v[92:93], v24 offset:20480
  ds_read_b64_tr_b16 v[94:95], v25 offset:20480
  s_waitcnt lgkmcnt(14)
  v_mfma_f32_32x32x16_bf16 v[128:143], v[64:67], v[48:51], v[128:143]
  s_waitcnt lgkmcnt(12)
  v_mfma_f32_32x32x16_bf16 v[144:159], v[68:71], v[48:51], v[144:159]
  s_waitcnt lgkmcnt(10)
  v_mfma_f32_32x32x16_bf16 v[96:111], v[72:75], v[48:51], v[96:111]
  s_waitcnt lgkmcnt(8)
  v_mfma_f32_32x32x16_bf16 v[112:127], v[76:79], v[48:51], v[112:127]
  s_waitcnt lgkmcnt(6)
  v_mfma_f32_32x32x16_bf16 v[128:143], v[80:83], v[52:55], v[128:143]
  s_waitcnt lgkmcnt(4)
  v_mfma_f32_32x32x16_bf16 v[144:159], v[84:87], v[52:55], v[144:159]
  s_waitcnt lgkmcnt(2)
  v_mfma_f32_32x32x16_bf16 v[96:111], v[88:91], v[52:55], v[96:111]
  s_waitcnt lgkmcnt(0)
  v_mfma_f32_32x32x16_bf16 v[112:127], v[92:95], v[52:55], v[112:127]
  s_waitcnt vmcnt(0)
  s_barrier
  ds_read_b64_tr_b16 v[64:65], v18 offset:0
  ds_read_b64_tr_b16 v[66:67], v19 offset:0
  ds_read_b64_tr_b16 v[68:69], v20 offset:0
  ds_read_b64_tr_b16 v[70:71], v21 offset:0
  ds_read_b64_tr_b16 v[72:73], v22 offset:0
  ds_read_b64_tr_b16 v[74:75], v23 offset:0
  ds_read_b64_tr_b16 v[76:77], v24 offset:0
  ds_read_b64_tr_b16 v[78:79], v25 offset:0
  ds_read_b64_tr_b16 v[80:81], v18 offset:4096
  ds_read_b64_tr_b16 v[82:83], v19 offset:4096
  ds_read_b64_tr_b16 v[84:85], v20 offset:4096
  ds_read_b64_tr_b16 v[86:87], v21 offset:4096
  ds_read_b64_tr_b16 v[88:89], v22 offset:4096
  ds_read_b64_tr_b16 v[90:91], v23 offset:4096
  ds_read_b64_tr_b16 v[92:93], v24 offset:4096
  ds_read_b64_tr_b16 v[94:95], v25 offset:4096
  s_waitcnt lgkmcnt(14)
  v_mfma_f32_32x32x16_bf16 v[128:143], v[64:67], v[56:59], v[128:143]
  s_waitcnt lgkmcnt(12)
  v_mfma_f32_32x32x16_bf16 v[144:159], v[68:71], v[56:59], v[144:159]
  s_waitcnt lgkmcnt(10)
  v_mfma_f32_32x32x16_bf16 v[96:111], v[72:75], v[56:59], v[96:111]
  s_waitcnt lgkmcnt(8)
  v_mfma_f32_32x32x16_bf16 v[112:127], v[76:79], v[56:59], v[112:127]
  s_waitcnt lgkmcnt(6)
  v_mfma_f32_32x32x16_bf16 v[128:143], v[80:83], v[60:63], v[128:143]
  s_waitcnt lgkmcnt(4)
  v_mfma_f32_32x32x16_bf16 v[144:159], v[84:87], v[60:63], v[144:159]
  s_waitcnt lgkmcnt(2)
  v_mfma_f32_32x32x16_bf16 v[96:111], v[88:91], v[60:63], v[96:111]
  s_waitcnt lgkmcnt(0)
  v_mfma_f32_32x32x16_bf16 v[112:127], v[92:95], v[60:63], v[112:127]
  v_add_f32 v34, v34, v35
  v_add_f32 v36, v36, v37
  v_add_f32 v34, v34, v36
  v_mov_b32 v35, v34
  s_nop 1
  v_permlane32_swap_b32 v34, v35
  s_nop 1
  v_add_f32 v33, v34, v35
  s_nop 15
  v_add_u32 v27, s75, v5
  s_xor_b32 s78, s4, 1
  s_mul_i32 s78, s78, 24576
  v_add_u32 v28, s78, v5
  v_lshlrev_b32 v29, 3, v0
  v_add_u32 v1, s78, v29
  v_add_u32 v29, s75, v29
  ds_write_b64 v29, v[32:33] offset:8192
  s_and_b32 s79, s4, 1
  s_cmp_eq_u32 s79, 1
  s_cbranch_scc1 L_k1_g1_j1
  ds_write_b128 v27, v[96:99] offset:0
  ds_write_b128 v27, v[100:103] offset:1024
  ds_write_b128 v27, v[104:107] offset:2048
  ds_write_b128 v27, v[108:111] offset:3072
  ds_write_b128 v27, v[112:115] offset:4096
  ds_write_b128 v27, v[116:119] offset:5120
  ds_write_b128 v27, v[120:123] offset:6144
  ds_write_b128 v27, v[124:127] offset:7168
  s_branch L_k1_g1_jd
L_k1_g1_j1:
  ds_write_b128 v27, v[128:131] offset:0
  ds_write_b128 v27, v[132:135] offset:1024
  ds_write_b128 v27, v[136:139] offset:2048
  ds_write_b128 v27, v[140:143] offset:3072
  ds_write_b128 v27, v[144:147] offset:4096
  ds_write_b128 v27, v[148:151] offset:5120
  ds_write_b128 v27, v[152:155] offset:6144
  ds_write_b128 v27, v[156:159] offset:7168
  s_waitcnt lgkmcnt(0)
  v_mov_b32 v128, v96
  v_mov_b32 v129, v97
  v_mov_b32 v130, v98
  v_mov_b32 v131, v99
  v_mov_b32 v132, v100
  v_mov_b32 v133, v101
  v_mov_b32 v134, v102
  v_mov_b32 v135, v103
  v_mov_b32 v136, v104
  v_mov_b32 v137, v105
  v_mov_b32 v138, v106
  v_mov_b32 v139, v107
  v_mov_b32 v140, v108
  v_mov_b32 v141, v109
  v_mov_b32 v142, v110
  v_mov_b32 v143, v111
  v_mov_b32 v144, v112
  v_mov_b32 v145, v113
  v_mov_b32 v146, v114
  v_mov_b32 v147, v115
  v_mov_b32 v148, v116
  v_mov_b32 v149, v117
  v_mov_b32 v150, v118
  v_mov_b32 v151, v119
  v_mov_b32 v152, v120
  v_mov_b32 v153, v121
  v_mov_b32 v154, v122
  v_mov_b32 v155, v123
  v_mov_b32 v156, v124
  v_mov_b32 v157, v125
  v_mov_b32 v158, v126
  v_mov_b32 v159, v127
L_k1_g1_jd:
  s_waitcnt lgkmcnt(0)
  s_barrier
  ds_read_b64 v[34:35], v1 offset:8192
  ds_read_b128 v[64:67], v28 offset:0
  ds_read_b128 v[68:71], v28 offset:1024
  ds_read_b128 v[72:75], v28 offset:2048
  ds_read_b128 v[76:79], v28 offset:3072
  ds_read_b128 v[80:83], v28 offset:4096
  ds_read_b128 v[84:87], v28 offset:5120
  ds_read_b128 v[88:91], v28 offset:6144
  ds_read_b128 v[92:95], v28 offset:7168
  s_waitcnt lgkmcnt(8)
  v_max_f32 v36, v32, v34
  v_sub_f32 v37, v32, v36
  v_sub_f32 v38, v34, v36
  v_mul_f32 v37, s76, v37
  v_mul_f32 v38, s76, v38
  v_exp_f32 v37, v37
  v_exp_f32 v38, v38
  s_nop 0
  v_mul_f32 v39, v33, v37
  v_fma_f32 v39, v35, v38, v39
  v_rcp_f32 v39, v39
  s_nop 0
  v_mul_f32 v37, v37, v39
  v_mul_f32 v38, v38, v39
  s_lshl_b32 s77, s12, 5
  s_add_u32 s77, s77, s11
  s_lshl_b32 s77, s77, 14
  s_lshl_b32 s78, s4, 12
  s_add_u32 s77, s77, s78
  s_waitcnt lgkmcnt(0)
  v_mul_f32 v128, v128, v37
  v_fma_f32 v128, v64, v38, v128
  v_mul_f32 v129, v129, v37
  v_fma_f32 v129, v65, v38, v129
  v_mul_f32 v130, v130, v37
  v_fma_f32 v130, v66, v38, v130
  v_mul_f32 v131, v131, v37
  v_fma_f32 v131, v67, v38, v131
  v_mul_f32 v132, v132, v37
  v_fma_f32 v132, v68, v38, v132
  v_mul_f32 v133, v133, v37
  v_fma_f32 v133, v69, v38, v133
  v_mul_f32 v134, v134, v37
  v_fma_f32 v134, v70, v38, v134
  v_mul_f32 v135, v135, v37
  v_fma_f32 v135, v71, v38, v135
  v_mul_f32 v136, v136, v37
  v_fma_f32 v136, v72, v38, v136
  v_mul_f32 v137, v137, v37
  v_fma_f32 v137, v73, v38, v137
  v_mul_f32 v138, v138, v37
  v_fma_f32 v138, v74, v38, v138
  v_mul_f32 v139, v139, v37
  v_fma_f32 v139, v75, v38, v139
  v_mul_f32 v140, v140, v37
  v_fma_f32 v140, v76, v38, v140
  v_mul_f32 v141, v141, v37
  v_fma_f32 v141, v77, v38, v141
  v_mul_f32 v142, v142, v37
  v_fma_f32 v142, v78, v38, v142
  v_mul_f32 v143, v143, v37
  v_fma_f32 v143, v79, v38, v143
  v_mul_f32 v144, v144, v37
  v_fma_f32 v144, v80, v38, v144
  v_mul_f32 v145, v145, v37
  v_fma_f32 v145, v81, v38, v145
  v_mul_f32 v146, v146, v37
  v_fma_f32 v146, v82, v38, v146
  v_mul_f32 v147, v147, v37
  v_fma_f32 v147, v83, v38, v147
  v_mul_f32 v148, v148, v37
  v_fma_f32 v148, v84, v38, v148
  v_mul_f32 v149, v149, v37
  v_fma_f32 v149, v85, v38, v149
  v_mul_f32 v150, v150, v37
  v_fma_f32 v150, v86, v38, v150
  v_mul_f32 v151, v151, v37
  v_fma_f32 v151, v87, v38, v151
  v_mul_f32 v152, v152, v37
  v_fma_f32 v152, v88, v38, v152
  v_mul_f32 v153, v153, v37
  v_fma_f32 v153, v89, v38, v153
  v_mul_f32 v154, v154, v37
  v_fma_f32 v154, v90, v38, v154
  v_mul_f32 v155, v155, v37
  v_fma_f32 v155, v91, v38, v155
  v_mul_f32 v156, v156, v37
  v_fma_f32 v156, v92, v38, v156
  v_mul_f32 v157, v157, v37
  v_fma_f32 v157, v93, v38, v157
  v_mul_f32 v158, v158, v37
  v_fma_f32 v158, v94, v38, v158
  v_mul_f32 v159, v159, v37
  v_fma_f32 v159, v95, v38, v159
  v_cvt_pk_bf16_f32 v64, v128, v129
  v_cvt_pk_bf16_f32 v65, v130, v131
  v_cvt_pk_bf16_f32 v66, v132, v133
  v_cvt_pk_bf16_f32 v67, v134, v135
  v_cvt_pk_bf16_f32 v68, v136, v137
  v_cvt_pk_bf16_f32 v69, v138, v139
  v_cvt_pk_bf16_f32 v70, v140, v141
  v_cvt_pk_bf16_f32 v71, v142, v143
  v_cvt_pk_bf16_f32 v72, v144, v145
  v_cvt_pk_bf16_f32 v73, v146, v147
  v_cvt_pk_bf16_f32 v74, v148, v149
  v_cvt_pk_bf16_f32 v75, v150, v151
  v_cvt_pk_bf16_f32 v76, v152, v153
  v_cvt_pk_bf16_f32 v77, v154, v155
  v_cvt_pk_bf16_f32 v78, v156, v157
  v_cvt_pk_bf16_f32 v79, v158, v159
  buffer_store_dwordx4 v[64:67], v5, s[60:63], s77 offen offset:0 sc1
  buffer_store_dwordx4 v[68:71], v5, s[60:63], s77 offen offset:1024 sc1
  buffer_store_dwordx4 v[72:75], v5, s[60:63], s77 offen offset:2048 sc1
  buffer_store_dwordx4 v[76:79], v5, s[60:63], s77 offen offset:3072 sc1
L_oproj:
  s_lshr_b32 s85, s7, 2
  s_and_b32 s86, s7, 3
  s_lshr_b32 s87, s8, 3
  s_and_b32 s13, s8, 7
  s_and_b32 s15, s3, 3
  s_lshr_b32 s6, s3, 2
  s_lshl_b32 s14, s2, 8
  v_lshlrev_b32 v34, 2, v0
  v_mov_b32 v33, 1
  v_mov_b32 v26, 0
  s_cmp_lg_u32 s3, 0
  s_cbranch_scc1 L_op_nocnt
  buffer_load_dword v35, v26, s[68:71], 0 offen sc1
L_op_nocnt:
  s_lshr_b32 s77, s10, 1
  s_lshl_b32 s77, s77, 6
  s_lshr_b32 s79, s9, 3
  s_add_u32 s77, s77, s79
  s_lshl_b32 s77, s77, 8
  s_and_b32 s79, s10, 1
  s_lshl_b32 s79, s79, 5
  s_add_u32 s77, s77, s79
  s_and_b32 s79, s9, 7
  s_lshl_b32 s79, s79, 2
  s_add_u32 s77, s77, s79
  s_lshr_b32 s78, s12, 1
  s_lshl_b32 s78, s78, 6
  s_lshr_b32 s79, s11, 3
  s_add_u32 s78, s78, s79
  s_add_u32 s78, s78, 4
  s_lshl_b32 s78, s78, 8
  s_and_b32 s79, s12, 1
  s_lshl_b32 s79, s79, 5
  s_add_u32 s78, s78, s79
  s_and_b32 s79, s11, 7
  s_lshl_b32 s79, s79, 2
  s_add_u32 s78, s78, s79
  v_mov_b32 v27, s77
  v_mov_b32 v28, s78
  v_cmp_gt_u32 vcc, 8, v0
  v_and_b32 v29, 7, v0
  v_lshlrev_b32 v29, 11, v29
  v_cndmask_b32 v32, v28, v27, vcc
  v_add_u32 v32, v32, v29
  s_lshl_b32 s77, s8, 3
  s_lshl_b32 s78, s85, 2
  s_add_u32 s77, s77, s78
  s_lshl_b32 s77, s77, 8
  s_lshl_b32 s78, s86, 2
  s_add_u32 s77, s77, s78
  s_add_u32 s77, s77, 64
  v_lshlrev_b32 v39, 8, v0
  v_add_u32 v39, s77, v39
  s_cmp_eq_u32 s85, 1
  s_cselect_b32 s48, s34, s24
  s_cselect_b32 s49, s35, s25
  s_and_b32 s49, s49, 0xffff
  s_mov_b32 s50, 0x800000
  s_mov_b32 s51, 0x20000
  s_mov_b32 s44, s40
  s_and_b32 s45, s41, 0xffff
  s_mov_b32 s46, 0x800000
  s_mov_b32 s47, 0x20000
  s_mov_b32 s52, s36
  s_and_b32 s53, s37, 0xffff
  s_mov_b32 s54, 0x200000
  s_mov_b32 s55, 0x20000
  s_add_u32 s56, s40, 0x2000000
  s_addc_u32 s57, s41, 0
  s_and_b32 s57, s57, 0xffff
  s_mov_b32 s58, 0x1000000
  s_mov_b32 s59, 0x20000
  s_lshl_b32 s72, s85, 22
  s_lshl_b32 s77, s87, 20
  s_add_u32 s72, s72, s77
  s_lshr_b32 s77, s15, 1
  s_lshl_b32 s77, s77, 19
  s_add_u32 s72, s72, s77
  s_lshl_b32 s77, s86, 17
  s_add_u32 s72, s72, s77
  s_and_b32 s77, s15, 1
  s_lshl_b32 s77, s77, 13
  s_add_u32 s72, s72, s77
  s_lshl_b32 s77, s6, 12
  s_add_u32 s72, s72, s77
  s_lshl_b32 s73, s86, 21
  s_lshl_b32 s77, s3, 15
  s_add_u32 s73, s73, s77
  s_lshl_b32 s77, s13, 8
  s_add_u32 s73, s73, s77
  s_lshl_b32 s74, s3, 12
  s_lshl_b32 s75, s87, 1
  s_add_u32 s75, s75, s13
  v_lshrrev_b32 v26, 4, v0
  v_and_b32 v27, 15, v0
  v_lshlrev_b32 v28, 2, v26
  v_xor_b32 v27, v27, v28
  v_lshlrev_b32 v27, 4, v27
  v_lshlrev_b32 v28, 11, v26
  v_add_u32 v6, v27, v28
  v_xor_b32 v7, 16, v6
  v_add_u32 v7, 7168, v7
  v_xor_b32 v8, 32, v6
  v_add_u32 v8, 14336, v8
  v_xor_b32 v9, 48, v6
  v_add_u32 v9, 21504, v9
  v_lshrrev_b32 v29, 5, v0
  v_and_b32 v27, 1, v26
  v_lshrrev_b32 v28, 2, v0
  v_and_b32 v28, 3, v28
  v_and_b32 v30, 1, v0
  v_lshlrev_b32 v30, 1, v30
  v_or_b32 v30, v30, v27
  v_lshlrev_b32 v30, 4, v30
  v_lshrrev_b32 v31, 1, v0
  v_and_b32 v31, 1, v31
  v_lshlrev_b32 v31, 3, v31
  v_add_u32 v30, v30, v31
  v_lshlrev_b32 v31, 6, v28
  v_add_u32 v30, v30, v31
  v_lshlrev_b32 v31, 4, v29
  v_add_u32 v31, v31, v28
  v_lshlrev_b32 v31, 8, v31
  v_add_u32 v30, v30, v31
  s_lshl_b32 s78, s6, 14
  v_add_u32 v10, s78, v30
  v_xor_b32 v11, 1040, v10
  v_xor_b32 v12, 2080, v10
  v_xor_b32 v13, 3120, v10
  v_xor_b32 v14, 64, v10
  v_xor_b32 v15, 1104, v10
  v_xor_b32 v16, 2144, v10
  v_xor_b32 v17, 3184, v10
  v_xor_b32 v18, 128, v10
  v_xor_b32 v19, 1168, v10
  v_xor_b32 v20, 2208, v10
  v_xor_b32 v21, 3248, v10
  v_xor_b32 v22, 192, v10
  v_xor_b32 v23, 1232, v10
  v_xor_b32 v24, 2272, v10
  v_xor_b32 v25, 3312, v10
  s_lshl_b32 s77, s3, 13
  v_add_u32 v36, s77, v5
  s_xor_b32 s77, s77, 32768
  v_add_u32 v37, s77, v5
  v_and_b32 v38, 31, v0
  v_lshlrev_b32 v38, 12, v38
  v_lshlrev_b32 v30, 5, v29
  v_add_u32 v38, v38, v30
  s_mov_b32 s80, 0
  s_add_u32 s77, s75, 0
  s_and_b32 s77, s77, 7
  s_lshl_b32 s77, s77, 0
  s_or_b32 s80, s80, s77
  s_add_u32 s77, s75, 1
  s_and_b32 s77, s77, 7
  s_lshl_b32 s77, s77, 4
  s_or_b32 s80, s80, s77
  s_add_u32 s77, s75, 2
  s_and_b32 s77, s77, 7
  s_lshl_b32 s77, s77, 8
  s_or_b32 s80, s80, s77
  s_add_u32 s77, s75, 3
  s_and_b32 s77, s77, 7
  s_lshl_b32 s77, s77, 12
  s_or_b32 s80, s80, s77
  s_add_u32 s77, s75, 4
  s_and_b32 s77, s77, 7
  s_lshl_b32 s77, s77, 16
  s_or_b32 s80, s80, s77
  s_add_u32 s77, s75, 5
  s_and_b32 s77, s77, 7
  s_lshl_b32 s77, s77, 20
  s_or_b32 s80, s80, s77
  s_add_u32 s77, s75, 6
  s_and_b32 s77, s77, 7
  s_lshl_b32 s77, s77, 24
  s_or_b32 s80, s80, s77
  s_add_u32 s77, s75, 7
  s_and_b32 s77, s77, 7
  s_lshl_b32 s77, s77, 28
  s_or_b32 s80, s80, s77
  s_cmp_lg_u32 s3, 0
  s_cbranch_scc1 L_op_noep
  buffer_load_dword v41, v34, s[64:67], s14 offen sc1
L_op_noep:
  s_waitcnt vmcnt(0)
  s_barrier
  s_cmp_lg_u32 s3, 0
  s_cbranch_scc1 L_op_w0done
  s_mov_b32 s82, 262144
L_op_cnt:
  v_readfirstlane_b32 s77, v35
  s_sub_u32 s82, s82, 1
  s_and_b32 s77, s77, 255
  s_cmp_eq_u32 s77, 0
  s_cbranch_scc1 L_op_cntok
  s_cmp_eq_u32 s82, 0
  s_cbranch_scc1 L_op_cntok
  s_sleep 16
  v_mov_b32 v26, 0
  buffer_load_dword v35, v26, s[68:71], 0 offen sc1
  s_waitcnt vmcnt(0)
  s_branch L_op_cnt
L_op_cntok:
  s_mov_b64 exec, 0xffff
  buffer_store_dword v33, v32, s[64:67], 0 offen sc1
  s_mov_b64 exec, -1
  v_cmp_eq_u32 vcc, 1, v41
  s_nop 3
  s_lshr_b32 s77, vcc_lo, 8
  s_and_b32 s77, s77, vcc_lo
  s_and_b32 s81, s77, 0xff
L_op_w0done:
  s_bfe_u32 s78, s80, 0x40000
  s_add_u32 m0, s74, 0
  s_lshl_b32 s78, s78, 18
  s_add_u32 s78, s78, s73
  buffer_load_dwordx4 v6, s[48:51], s78 offen lds
  buffer_load_dwordx4 v7, s[48:51], s78 offen offset:1024 lds
  buffer_load_dwordx4 v8, s[48:51], s78 offen offset:2048 lds
  buffer_load_dwordx4 v9, s[48:51], s78 offen offset:3072 lds
  s_bfe_u32 s78, s80, 0x40004
  s_add_u32 m0, s74, 32768
  s_lshl_b32 s78, s78, 18
  s_add_u32 s78, s78, s73
  buffer_load_dwordx4 v6, s[48:51], s78 offen lds
  buffer_load_dwordx4 v7, s[48:51], s78 offen offset:1024 lds
  buffer_load_dwordx4 v8, s[48:51], s78 offen offset:2048 lds
  buffer_load_dwordx4 v9, s[48:51], s78 offen offset:3072 lds
  s_cmp_lg_u32 s3, 0
  s_cbranch_scc1 L_op_n0r
  s_mov_b32 s82, 262144
L_op_n0c:
  s_bfe_u32 s79, s80, 0x40000
  s_bitcmp1_b32 s81, s79
  s_cbranch_scc1 L_op_n0r
  s_sub_u32 s82, s82, 1
  s_cmp_eq_u32 s82, 0
  s_cbranch_scc1 L_op_n0r
  buffer_load_dword v28, v34, s[64:67], s14 offen sc1
  s_waitcnt vmcnt(0)
  v_cmp_eq_u32 vcc, 1, v28
  s_nop 3
  s_lshr_b32 s77, vcc_lo, 8
  s_and_b32 s77, s77, vcc_lo
  s_and_b32 s77, s77, 0xff
  s_and_b32 s81, vcc_lo, 0xf0000
  s_or_b32 s81, s81, s77
  s_branch L_op_n0c
L_op_n0r:
  s_cmp_lg_u32 s3, 0
  s_cbranch_scc1 L_op_n1r
  s_mov_b32 s82, 262144
L_op_n1c:
  s_bfe_u32 s79, s80, 0x40004
  s_bitcmp1_b32 s81, s79
  s_cbranch_scc1 L_op_n1r
  s_sub_u32 s82, s82, 1
  s_cmp_eq_u32 s82, 0
  s_cbranch_scc1 L_op_n1r
  buffer_load_dword v28, v34, s[64:67], s14 offen sc1
  s_waitcnt vmcnt(0)
  v_cmp_eq_u32 vcc, 1, v28
  s_nop 3
  s_lshr_b32 s77, vcc_lo, 8
  s_and_b32 s77, s77, vcc_lo
  s_and_b32 s77, s77, 0xff
  s_and_b32 s81, vcc_lo, 0xf0000
  s_or_b32 s81, s81, s77
  s_branch L_op_n1c
L_op_n1r:
  s_barrier
  s_bfe_u32 s77, s80, 0x40000
  s_lshl_b32 s77, s77, 14
  s_add_u32 s77, s77, s72
  buffer_load_dwordx4 v[80:83], v5, s[44:47], s77 offen sc1
  buffer_load_dwordx4 v[84:87], v5, s[44:47], s77 offen offset:1024 sc1
  buffer_load_dwordx4 v[88:91], v5, s[44:47], s77 offen offset:2048 sc1
  buffer_load_dwordx4 v[92:95], v5, s[44:47], s77 offen offset:3072 sc1
  s_bfe_u32 s77, s80, 0x40004
  s_lshl_b32 s77, s77, 14
  s_add_u32 s77, s77, s72
  buffer_load_dwordx4 v[96:99], v5, s[44:47], s77 offen sc1
  buffer_load_dwordx4 v[100:103], v5, s[44:47], s77 offen offset:1024 sc1
  buffer_load_dwordx4 v[104:107], v5, s[44:47], s77 offen offset:2048 sc1
  buffer_load_dwordx4 v[108:111], v5, s[44:47], s77 offen offset:3072 sc1
  s_bfe_u32 s78, s80, 0x40008
  s_add_u32 m0, s74, 65536
  s_lshl_b32 s78, s78, 18
  s_add_u32 s78, s78, s73
  buffer_load_dwordx4 v6, s[48:51], s78 offen lds
  buffer_load_dwordx4 v7, s[48:51], s78 offen offset:1024 lds
  buffer_load_dwordx4 v8, s[48:51], s78 offen offset:2048 lds
  buffer_load_dwordx4 v9, s[48:51], s78 offen offset:3072 lds
  s_bfe_u32 s78, s80, 0x4000c
  s_add_u32 m0, s74, 98304
  s_lshl_b32 s78, s78, 18
  s_add_u32 s78, s78, s73
  buffer_load_dwordx4 v6, s[48:51], s78 offen lds
  buffer_load_dwordx4 v7, s[48:51], s78 offen offset:1024 lds
  buffer_load_dwordx4 v8, s[48:51], s78 offen offset:2048 lds
  buffer_load_dwordx4 v9, s[48:51], s78 offen offset:3072 lds
  s_cmp_lg_u32 s3, 0
  s_cbranch_scc1 L_op_rdy0
  s_mov_b32 s82, 262144
L_op_chk0:
  s_bfe_u32 s79, s80, 0x40008
  s_bitcmp1_b32 s81, s79
  s_cbranch_scc1 L_op_rdy0
  s_sub_u32 s82, s82, 1
  s_cmp_eq_u32 s82, 0
  s_cbranch_scc1 L_op_rdy0
  buffer_load_dword v28, v34, s[64:67], s14 offen sc1
  s_waitcnt vmcnt(0)
  v_cmp_eq_u32 vcc, 1, v28
  s_nop 3
  s_lshr_b32 s77, vcc_lo, 8
  s_and_b32 s77, s77, vcc_lo
  s_and_b32 s77, s77, 0xff
  s_and_b32 s81, vcc_lo, 0xf0000
  s_or_b32 s81, s81, s77
  s_branch L_op_chk0
L_op_rdy0:
  s_waitcnt vmcnt(12)
  s_barrier
  ds_read_b64_tr_b16 v[128:129], v10 offset:0
  ds_read_b64_tr_b16 v[130:131], v11 offset:0
  ds_read_b64_tr_b16 v[132:133], v14 offset:0
  ds_read_b64_tr_b16 v[134:135], v15 offset:0
  ds_read_b64_tr_b16 v[136:137], v18 offset:0
  ds_read_b64_tr_b16 v[138:139], v19 offset:0
  ds_read_b64_tr_b16 v[140:141], v22 offset:0
  ds_read_b64_tr_b16 v[142:143], v23 offset:0
  ds_read_b64_tr_b16 v[144:145], v12 offset:0
  ds_read_b64_tr_b16 v[146:147], v13 offset:0
  ds_read_b64_tr_b16 v[148:149], v16 offset:0
  ds_read_b64_tr_b16 v[150:151], v17 offset:0
  ds_read_b64_tr_b16 v[152:153], v20 offset:0
  ds_read_b64_tr_b16 v[154:155], v21 offset:0
  ds_read_b64_tr_b16 v[156:157], v24 offset:0
  ds_read_b64_tr_b16 v[158:159], v25 offset:0
  s_waitcnt lgkmcnt(8)
  v_mfma_f32_32x32x16_bf16 v[192:207], v[128:131], v[80:83], 0
  ds_read_b64_tr_b16 v[160:161], v10 offset:8192
  ds_read_b64_tr_b16 v[162:163], v11 offset:8192
  ds_read_b64_tr_b16 v[164:165], v14 offset:8192
  ds_read_b64_tr_b16 v[166:167], v15 offset:8192
  ds_read_b64_tr_b16 v[168:169], v18 offset:8192
  ds_read_b64_tr_b16 v[170:171], v19 offset:8192
  ds_read_b64_tr_b16 v[172:173], v22 offset:8192
  ds_read_b64_tr_b16 v[174:175], v23 offset:8192
  v_mfma_f32_32x32x16_bf16 v[208:223], v[132:135], v[80:83], 0
  s_bfe_u32 s77, s80, 0x40008
  s_lshl_b32 s77, s77, 14
  s_add_u32 s77, s77, s72
  buffer_load_dwordx4 v[112:115], v5, s[44:47], s77 offen sc1
  v_mfma_f32_32x32x16_bf16 v[224:239], v[136:139], v[80:83], 0
  buffer_load_dwordx4 v[116:119], v5, s[44:47], s77 offen offset:1024 sc1
  v_mfma_f32_32x32x16_bf16 v[240:255], v[140:143], v[80:83], 0
  buffer_load_dwordx4 v[120:123], v5, s[44:47], s77 offen offset:2048 sc1
  s_waitcnt lgkmcnt(8)
  v_mfma_f32_32x32x16_bf16 v[192:207], v[144:147], v[84:87], v[192:207]
  ds_read_b64_tr_b16 v[128:129], v12 offset:8192
  ds_read_b64_tr_b16 v[130:131], v13 offset:8192
  ds_read_b64_tr_b16 v[132:133], v16 offset:8192
  ds_read_b64_tr_b16 v[134:135], v17 offset:8192
  ds_read_b64_tr_b16 v[136:137], v20 offset:8192
  ds_read_b64_tr_b16 v[138:139], v21 offset:8192
  ds_read_b64_tr_b16 v[140:141], v24 offset:8192
  ds_read_b64_tr_b16 v[142:143], v25 offset:8192
  v_mfma_f32_32x32x16_bf16 v[208:223], v[148:151], v[84:87], v[208:223]
  buffer_load_dwordx4 v[124:127], v5, s[44:47], s77 offen offset:3072 sc1
  v_mfma_f32_32x32x16_bf16 v[224:239], v[152:155], v[84:87], v[224:239]
  s_bfe_u32 s78, s80, 0x40010
  s_add_u32 m0, s74, 131072
  s_lshl_b32 s78, s78, 18
  s_add_u32 s78, s78, s73
  buffer_load_dwordx4 v6, s[48:51], s78 offen lds
  v_mfma_f32_32x32x16_bf16 v[240:255], v[156:159], v[84:87], v[240:255]
  buffer_load_dwordx4 v7, s[48:51], s78 offen offset:1024 lds
  s_waitcnt lgkmcnt(8)
  v_mfma_f32_32x32x16_bf16 v[192:207], v[160:163], v[88:91], v[192:207]
  v_mfma_f32_32x32x16_bf16 v[208:223], v[164:167], v[88:91], v[208:223]
  buffer_load_dwordx4 v8, s[48:51], s78 offen offset:2048 lds
  v_mfma_f32_32x32x16_bf16 v[224:239], v[168:171], v[88:91], v[224:239]
  buffer_load_dwordx4 v9, s[48:51], s78 offen offset:3072 lds
  v_mfma_f32_32x32x16_bf16 v[240:255], v[172:175], v[88:91], v[240:255]
  s_waitcnt lgkmcnt(0)
  s_cmp_lg_u32 s3, 0
  s_cbranch_scc1 L_op_rdy1
  s_mov_b32 s82, 262144
L_op_chk1:
  s_bfe_u32 s79, s80, 0x4000c
  s_bitcmp1_b32 s81, s79
  s_cbranch_scc1 L_op_rdy1
  s_sub_u32 s82, s82, 1
  s_cmp_eq_u32 s82, 0
  s_cbranch_scc1 L_op_rdy1
  buffer_load_dword v28, v34, s[64:67], s14 offen sc1
  s_waitcnt vmcnt(0)
  v_cmp_eq_u32 vcc, 1, v28
  s_nop 3
  s_lshr_b32 s77, vcc_lo, 8
  s_and_b32 s77, s77, vcc_lo
  s_and_b32 s77, s77, 0xff
  s_and_b32 s81, vcc_lo, 0xf0000
  s_or_b32 s81, s81, s77
  s_branch L_op_chk1
L_op_rdy1:
  s_waitcnt vmcnt(16)
  s_barrier
  ds_read_b64_tr_b16 v[144:145], v10 offset:32768
  ds_read_b64_tr_b16 v[146:147], v11 offset:32768
  ds_read_b64_tr_b16 v[148:149], v14 offset:32768
  ds_read_b64_tr_b16 v[150:151], v15 offset:32768
  ds_read_b64_tr_b16 v[152:153], v18 offset:32768
  ds_read_b64_tr_b16 v[154:155], v19 offset:32768
  ds_read_b64_tr_b16 v[156:157], v22 offset:32768
  ds_read_b64_tr_b16 v[158:159], v23 offset:32768
  v_mfma_f32_32x32x16_bf16 v[192:207], v[128:131], v[92:95], v[192:207]
  v_mfma_f32_32x32x16_bf16 v[208:223], v[132:135], v[92:95], v[208:223]
  ds_read_b64_tr_b16 v[160:161], v12 offset:32768
  ds_read_b64_tr_b16 v[162:163], v13 offset:32768
  ds_read_b64_tr_b16 v[164:165], v16 offset:32768
  ds_read_b64_tr_b16 v[166:167], v17 offset:32768
  ds_read_b64_tr_b16 v[168:169], v20 offset:32768
  ds_read_b64_tr_b16 v[170:171], v21 offset:32768
  ds_read_b64_tr_b16 v[172:173], v24 offset:32768
  ds_read_b64_tr_b16 v[174:175], v25 offset:32768
  v_mfma_f32_32x32x16_bf16 v[224:239], v[136:139], v[92:95], v[224:239]
  v_mfma_f32_32x32x16_bf16 v[240:255], v[140:143], v[92:95], v[240:255]
  s_waitcnt lgkmcnt(8)
  v_mfma_f32_32x32x16_bf16 v[192:207], v[144:147], v[96:99], v[192:207]
  ds_read_b64_tr_b16 v[128:129], v10 offset:40960
  ds_read_b64_tr_b16 v[130:131], v11 offset:40960
  ds_read_b64_tr_b16 v[132:133], v14 offset:40960
  ds_read_b64_tr_b16 v[134:135], v15 offset:40960
  ds_read_b64_tr_b16 v[136:137], v18 offset:40960
  ds_read_b64_tr_b16 v[138:139], v19 offset:40960
  ds_read_b64_tr_b16 v[140:141], v22 offset:40960
  ds_read_b64_tr_b16 v[142:143], v23 offset:40960
  v_mfma_f32_32x32x16_bf16 v[208:223], v[148:151], v[96:99], v[208:223]
  s_bfe_u32 s77, s80, 0x4000c
  s_lshl_b32 s77, s77, 14
  s_add_u32 s77, s77, s72
  buffer_load_dwordx4 v[80:83], v5, s[44:47], s77 offen sc1
  v_mfma_f32_32x32x16_bf16 v[224:239], v[152:155], v[96:99], v[224:239]
  buffer_load_dwordx4 v[84:87], v5, s[44:47], s77 offen offset:1024 sc1
  v_mfma_f32_32x32x16_bf16 v[240:255], v[156:159], v[96:99], v[240:255]
  buffer_load_dwordx4 v[88:91], v5, s[44:47], s77 offen offset:2048 sc1
  s_waitcnt lgkmcnt(8)
  v_mfma_f32_32x32x16_bf16 v[192:207], v[160:163], v[100:103], v[192:207]
  ds_read_b64_tr_b16 v[144:145], v12 offset:40960
  ds_read_b64_tr_b16 v[146:147], v13 offset:40960
  ds_read_b64_tr_b16 v[148:149], v16 offset:40960
  ds_read_b64_tr_b16 v[150:151], v17 offset:40960
  ds_read_b64_tr_b16 v[152:153], v20 offset:40960
  ds_read_b64_tr_b16 v[154:155], v21 offset:40960
  ds_read_b64_tr_b16 v[156:157], v24 offset:40960
  ds_read_b64_tr_b16 v[158:159], v25 offset:40960
  v_mfma_f32_32x32x16_bf16 v[208:223], v[164:167], v[100:103], v[208:223]
  buffer_load_dwordx4 v[92:95], v5, s[44:47], s77 offen offset:3072 sc1
  v_mfma_f32_32x32x16_bf16 v[224:239], v[168:171], v[100:103], v[224:239]
  s_bfe_u32 s78, s80, 0x40014
  s_add_u32 m0, s74, 0
  s_lshl_b32 s78, s78, 18
  s_add_u32 s78, s78, s73
  buffer_load_dwordx4 v6, s[48:51], s78 offen lds
  v_mfma_f32_32x32x16_bf16 v[240:255], v[172:175], v[100:103], v[240:255]
  buffer_load_dwordx4 v7, s[48:51], s78 offen offset:1024 lds
  s_waitcnt lgkmcnt(8)
  v_mfma_f32_32x32x16_bf16 v[192:207], v[128:131], v[104:107], v[192:207]
  v_mfma_f32_32x32x16_bf16 v[208:223], v[132:135], v[104:107], v[208:223]
  buffer_load_dwordx4 v8, s[48:51], s78 offen offset:2048 lds
  v_mfma_f32_32x32x16_bf16 v[224:239], v[136:139], v[104:107], v[224:239]
  buffer_load_dwordx4 v9, s[48:51], s78 offen offset:3072 lds
  v_mfma_f32_32x32x16_bf16 v[240:255], v[140:143], v[104:107], v[240:255]
  s_waitcnt lgkmcnt(0)
  v_add_u32 v10, 0x10000, v10
  v_add_u32 v11, 0x10000, v11
  v_add_u32 v12, 0x10000, v12
  v_add_u32 v13, 0x10000, v13
  v_add_u32 v14, 0x10000, v14
  v_add_u32 v15, 0x10000, v15
  v_add_u32 v16, 0x10000, v16
  v_add_u32 v17, 0x10000, v17
  v_add_u32 v18, 0x10000, v18
  v_add_u32 v19, 0x10000, v19
  v_add_u32 v20, 0x10000, v20
  v_add_u32 v21, 0x10000, v21
  v_add_u32 v22, 0x10000, v22
  v_add_u32 v23, 0x10000, v23
  v_add_u32 v24, 0x10000, v24
  v_add_u32 v25, 0x10000, v25
  s_cmp_lg_u32 s3, 0
  s_cbranch_scc1 L_op_rdy2
  s_mov_b32 s82, 262144
L_op_chk2:
  s_bfe_u32 s79, s80, 0x40010
  s_bitcmp1_b32 s81, s79
  s_cbranch_scc1 L_op_rdy2
  s_sub_u32 s82, s82, 1
  s_cmp_eq_u32 s82, 0
  s_cbranch_scc1 L_op_rdy2
  buffer_load_dword v28, v34, s[64:67], s14 offen sc1
  s_waitcnt vmcnt(0)
  v_cmp_eq_u32 vcc, 1, v28
  s_nop 3
  s_lshr_b32 s77, vcc_lo, 8
  s_and_b32 s77, s77, vcc_lo
  s_and_b32 s77, s77, 0xff
  s_and_b32 s81, vcc_lo, 0xf0000
  s_or_b32 s81, s81, s77
  s_branch L_op_chk2
L_op_rdy2:
  s_waitcnt vmcnt(12)
  s_barrier
  ds_read_b64_tr_b16 v[160:161], v10 offset:0
  ds_read_b64_tr_b16 v[162:163], v11 offset:0
  ds_read_b64_tr_b16 v[164:165], v14 offset:0
  ds_read_b64_tr_b16 v[166:167], v15 offset:0
  ds_read_b64_tr_b16 v[168:169], v18 offset:0
  ds_read_b64_tr_b16 v[170:171], v19 offset:0
  ds_read_b64_tr_b16 v[172:173], v22 offset:0
  ds_read_b64_tr_b16 v[174:175], v23 offset:0
  v_mfma_f32_32x32x16_bf16 v[192:207], v[144:147], v[108:111], v[192:207]
  v_mfma_f32_32x32x16_bf16 v[208:223], v[148:151], v[108:111], v[208:223]
  ds_read_b64_tr_b16 v[128:129], v12 offset:0
  ds_read_b64_tr_b16 v[130:131], v13 offset:0
  ds_read_b64_tr_b16 v[132:133], v16 offset:0
  ds_read_b64_tr_b16 v[134:135], v17 offset:0
  ds_read_b64_tr_b16 v[136:137], v20 offset:0
  ds_read_b64_tr_b16 v[138:139], v21 offset:0
  ds_read_b64_tr_b16 v[140:141], v24 offset:0
  ds_read_b64_tr_b16 v[142:143], v25 offset:0
  v_mfma_f32_32x32x16_bf16 v[224:239], v[152:155], v[108:111], v[224:239]
  v_mfma_f32_32x32x16_bf16 v[240:255], v[156:159], v[108:111], v[240:255]
  s_waitcnt lgkmcnt(8)
  v_mfma_f32_32x32x16_bf16 v[192:207], v[160:163], v[112:115], v[192:207]
  ds_read_b64_tr_b16 v[144:145], v10 offset:8192
  ds_read_b64_tr_b16 v[146:147], v11 offset:8192
  ds_read_b64_tr_b16 v[148:149], v14 offset:8192
  ds_read_b64_tr_b16 v[150:151], v15 offset:8192
  ds_read_b64_tr_b16 v[152:153], v18 offset:8192
  ds_read_b64_tr_b16 v[154:155], v19 offset:8192
  ds_read_b64_tr_b16 v[156:157], v22 offset:8192
  ds_read_b64_tr_b16 v[158:159], v23 offset:8192
  v_mfma_f32_32x32x16_bf16 v[208:223], v[164:167], v[112:115], v[208:223]
  s_bfe_u32 s77, s80, 0x40010
  s_lshl_b32 s77, s77, 14
  s_add_u32 s77, s77, s72
  buffer_load_dwordx4 v[96:99], v5, s[44:47], s77 offen sc1
  v_mfma_f32_32x32x16_bf16 v[224:239], v[168:171], v[112:115], v[224:239]
  buffer_load_dwordx4 v[100:103], v5, s[44:47], s77 offen offset:1024 sc1
  v_mfma_f32_32x32x16_bf16 v[240:255], v[172:175], v[112:115], v[240:255]
  buffer_load_dwordx4 v[104:107], v5, s[44:47], s77 offen offset:2048 sc1
  s_waitcnt lgkmcnt(8)
  v_mfma_f32_32x32x16_bf16 v[192:207], v[128:131], v[116:119], v[192:207]
  ds_read_b64_tr_b16 v[160:161], v12 offset:8192
  ds_read_b64_tr_b16 v[162:163], v13 offset:8192
  ds_read_b64_tr_b16 v[164:165], v16 offset:8192
  ds_read_b64_tr_b16 v[166:167], v17 offset:8192
  ds_read_b64_tr_b16 v[168:169], v20 offset:8192
  ds_read_b64_tr_b16 v[170:171], v21 offset:8192
  ds_read_b64_tr_b16 v[172:173], v24 offset:8192
  ds_read_b64_tr_b16 v[174:175], v25 offset:8192
  v_mfma_f32_32x32x16_bf16 v[208:223], v[132:135], v[116:119], v[208:223]
  buffer_load_dwordx4 v[108:111], v5, s[44:47], s77 offen offset:3072 sc1
  v_mfma_f32_32x32x16_bf16 v[224:239], v[136:139], v[116:119], v[224:239]
  s_bfe_u32 s78, s80, 0x40018
  s_add_u32 m0, s74, 32768
  s_lshl_b32 s78, s78, 18
  s_add_u32 s78, s78, s73
  buffer_load_dwordx4 v6, s[48:51], s78 offen lds
  v_mfma_f32_32x32x16_bf16 v[240:255], v[140:143], v[116:119], v[240:255]
  buffer_load_dwordx4 v7, s[48:51], s78 offen offset:1024 lds
  s_waitcnt lgkmcnt(8)
  v_mfma_f32_32x32x16_bf16 v[192:207], v[144:147], v[120:123], v[192:207]
  v_mfma_f32_32x32x16_bf16 v[208:223], v[148:151], v[120:123], v[208:223]
  buffer_load_dwordx4 v8, s[48:51], s78 offen offset:2048 lds
  v_mfma_f32_32x32x16_bf16 v[224:239], v[152:155], v[120:123], v[224:239]
  buffer_load_dwordx4 v9, s[48:51], s78 offen offset:3072 lds
  v_mfma_f32_32x32x16_bf16 v[240:255], v[156:159], v[120:123], v[240:255]
  s_waitcnt lgkmcnt(0)
  s_cmp_lg_u32 s3, 0
  s_cbranch_scc1 L_op_rdy3
  s_mov_b32 s82, 262144
L_op_chk3:
  s_bfe_u32 s79, s80, 0x40014
  s_bitcmp1_b32 s81, s79
  s_cbranch_scc1 L_op_rdy3
  s_sub_u32 s82, s82, 1
  s_cmp_eq_u32 s82, 0
  s_cbranch_scc1 L_op_rdy3
  buffer_load_dword v28, v34, s[64:67], s14 offen sc1
  s_waitcnt vmcnt(0)
  v_cmp_eq_u32 vcc, 1, v28
  s_nop 3
  s_lshr_b32 s77, vcc_lo, 8
  s_and_b32 s77, s77, vcc_lo
  s_and_b32 s77, s77, 0xff
  s_and_b32 s81, vcc_lo, 0xf0000
  s_or_b32 s81, s81, s77
  s_branch L_op_chk3
L_op_rdy3:
  s_waitcnt vmcnt(12)
  s_barrier
  ds_read_b64_tr_b16 v[128:129], v10 offset:32768
  ds_read_b64_tr_b16 v[130:131], v11 offset:32768
  ds_read_b64_tr_b16 v[132:133], v14 offset:32768
  ds_read_b64_tr_b16 v[134:135], v15 offset:32768
  ds_read_b64_tr_b16 v[136:137], v18 offset:32768
  ds_read_b64_tr_b16 v[138:139], v19 offset:32768
  ds_read_b64_tr_b16 v[140:141], v22 offset:32768
  ds_read_b64_tr_b16 v[142:143], v23 offset:32768
  v_mfma_f32_32x32x16_bf16 v[192:207], v[160:163], v[124:127], v[192:207]
  v_mfma_f32_32x32x16_bf16 v[208:223], v[164:167], v[124:127], v[208:223]
  ds_read_b64_tr_b16 v[144:145], v12 offset:32768
  ds_read_b64_tr_b16 v[146:147], v13 offset:32768
  ds_read_b64_tr_b16 v[148:149], v16 offset:32768
  ds_read_b64_tr_b16 v[150:151], v17 offset:32768
  ds_read_b64_tr_b16 v[152:153], v20 offset:32768
  ds_read_b64_tr_b16 v[154:155], v21 offset:32768
  ds_read_b64_tr_b16 v[156:157], v24 offset:32768
  ds_read_b64_tr_b16 v[158:159], v25 offset:32768
  v_mfma_f32_32x32x16_bf16 v[224:239], v[168:171], v[124:127], v[224:239]
  v_mfma_f32_32x32x16_bf16 v[240:255], v[172:175], v[124:127], v[240:255]
  s_waitcnt lgkmcnt(8)
  v_mfma_f32_32x32x16_bf16 v[192:207], v[128:131], v[80:83], v[192:207]
  ds_read_b64_tr_b16 v[160:161], v10 offset:40960
  ds_read_b64_tr_b16 v[162:163], v11 offset:40960
  ds_read_b64_tr_b16 v[164:165], v14 offset:40960
  ds_read_b64_tr_b16 v[166:167], v15 offset:40960
  ds_read_b64_tr_b16 v[168:169], v18 offset:40960
  ds_read_b64_tr_b16 v[170:171], v19 offset:40960
  ds_read_b64_tr_b16 v[172:173], v22 offset:40960
  ds_read_b64_tr_b16 v[174:175], v23 offset:40960
  v_mfma_f32_32x32x16_bf16 v[208:223], v[132:135], v[80:83], v[208:223]
  s_bfe_u32 s77, s80, 0x40014
  s_lshl_b32 s77, s77, 14
  s_add_u32 s77, s77, s72
  buffer_load_dwordx4 v[112:115], v5, s[44:47], s77 offen sc1
  v_mfma_f32_32x32x16_bf16 v[224:239], v[136:139], v[80:83], v[224:239]
  buffer_load_dwordx4 v[116:119], v5, s[44:47], s77 offen offset:1024 sc1
  v_mfma_f32_32x32x16_bf16 v[240:255], v[140:143], v[80:83], v[240:255]
  buffer_load_dwordx4 v[120:123], v5, s[44:47], s77 offen offset:2048 sc1
  s_waitcnt lgkmcnt(8)
  v_mfma_f32_32x32x16_bf16 v[192:207], v[144:147], v[84:87], v[192:207]
  ds_read_b64_tr_b16 v[128:129], v12 offset:40960
  ds_read_b64_tr_b16 v[130:131], v13 offset:40960
  ds_read_b64_tr_b16 v[132:133], v16 offset:40960
  ds_read_b64_tr_b16 v[134:135], v17 offset:40960
  ds_read_b64_tr_b16 v[136:137], v20 offset:40960
  ds_read_b64_tr_b16 v[138:139], v21 offset:40960
  ds_read_b64_tr_b16 v[140:141], v24 offset:40960
  ds_read_b64_tr_b16 v[142:143], v25 offset:40960
  v_mfma_f32_32x32x16_bf16 v[208:223], v[148:151], v[84:87], v[208:223]
  buffer_load_dwordx4 v[124:127], v5, s[44:47], s77 offen offset:3072 sc1
  v_mfma_f32_32x32x16_bf16 v[224:239], v[152:155], v[84:87], v[224:239]
  s_bfe_u32 s78, s80, 0x4001c
  s_add_u32 m0, s74, 65536
  s_lshl_b32 s78, s78, 18
  s_add_u32 s78, s78, s73
  buffer_load_dwordx4 v6, s[48:51], s78 offen lds
  v_mfma_f32_32x32x16_bf16 v[240:255], v[156:159], v[84:87], v[240:255]
  buffer_load_dwordx4 v7, s[48:51], s78 offen offset:1024 lds
  s_waitcnt lgkmcnt(8)
  v_mfma_f32_32x32x16_bf16 v[192:207], v[160:163], v[88:91], v[192:207]
  v_mfma_f32_32x32x16_bf16 v[208:223], v[164:167], v[88:91], v[208:223]
  buffer_load_dwordx4 v8, s[48:51], s78 offen offset:2048 lds
  v_mfma_f32_32x32x16_bf16 v[224:239], v[168:171], v[88:91], v[224:239]
  buffer_load_dwordx4 v9, s[48:51], s78 offen offset:3072 lds
  v_mfma_f32_32x32x16_bf16 v[240:255], v[172:175], v[88:91], v[240:255]
  s_waitcnt lgkmcnt(0)
  v_add_u32 v10, 0x10000, v10
  v_add_u32 v11, 0x10000, v11
  v_add_u32 v12, 0x10000, v12
  v_add_u32 v13, 0x10000, v13
  v_add_u32 v14, 0x10000, v14
  v_add_u32 v15, 0x10000, v15
  v_add_u32 v16, 0x10000, v16
  v_add_u32 v17, 0x10000, v17
  v_add_u32 v18, 0x10000, v18
  v_add_u32 v19, 0x10000, v19
  v_add_u32 v20, 0x10000, v20
  v_add_u32 v21, 0x10000, v21
  v_add_u32 v22, 0x10000, v22
  v_add_u32 v23, 0x10000, v23
  v_add_u32 v24, 0x10000, v24
  v_add_u32 v25, 0x10000, v25
  s_cmp_lg_u32 s3, 0
  s_cbranch_scc1 L_op_rdy4
  s_mov_b32 s82, 262144
L_op_chk4:
  s_bfe_u32 s79, s80, 0x40018
  s_bitcmp1_b32 s81, s79
  s_cbranch_scc1 L_op_rdy4
  s_sub_u32 s82, s82, 1
  s_cmp_eq_u32 s82, 0
  s_cbranch_scc1 L_op_rdy4
  buffer_load_dword v28, v34, s[64:67], s14 offen sc1
  s_waitcnt vmcnt(0)
  v_cmp_eq_u32 vcc, 1, v28
  s_nop 3
  s_lshr_b32 s77, vcc_lo, 8
  s_and_b32 s77, s77, vcc_lo
  s_and_b32 s77, s77, 0xff
  s_and_b32 s81, vcc_lo, 0xf0000
  s_or_b32 s81, s81, s77
  s_branch L_op_chk4
L_op_rdy4:
  s_waitcnt vmcnt(12)
  s_barrier
  ds_read_b64_tr_b16 v[144:145], v10 offset:0
  ds_read_b64_tr_b16 v[146:147], v11 offset:0
  ds_read_b64_tr_b16 v[148:149], v14 offset:0
  ds_read_b64_tr_b16 v[150:151], v15 offset:0
  ds_read_b64_tr_b16 v[152:153], v18 offset:0
  ds_read_b64_tr_b16 v[154:155], v19 offset:0
  ds_read_b64_tr_b16 v[156:157], v22 offset:0
  ds_read_b64_tr_b16 v[158:159], v23 offset:0
  v_mfma_f32_32x32x16_bf16 v[192:207], v[128:131], v[92:95], v[192:207]
  v_mfma_f32_32x32x16_bf16 v[208:223], v[132:135], v[92:95], v[208:223]
  ds_read_b64_tr_b16 v[160:161], v12 offset:0
  ds_read_b64_tr_b16 v[162:163], v13 offset:0
  ds_read_b64_tr_b16 v[164:165], v16 offset:0
  ds_read_b64_tr_b16 v[166:167], v17 offset:0
  ds_read_b64_tr_b16 v[168:169], v20 offset:0
  ds_read_b64_tr_b16 v[170:171], v21 offset:0
  ds_read_b64_tr_b16 v[172:173], v24 offset:0
  ds_read_b64_tr_b16 v[174:175], v25 offset:0
  v_mfma_f32_32x32x16_bf16 v[224:239], v[136:139], v[92:95], v[224:239]
  v_mfma_f32_32x32x16_bf16 v[240:255], v[140:143], v[92:95], v[240:255]
  s_waitcnt lgkmcnt(8)
  v_mfma_f32_32x32x16_bf16 v[192:207], v[144:147], v[96:99], v[192:207]
  ds_read_b64_tr_b16 v[128:129], v10 offset:8192
  ds_read_b64_tr_b16 v[130:131], v11 offset:8192
  ds_read_b64_tr_b16 v[132:133], v14 offset:8192
  ds_read_b64_tr_b16 v[134:135], v15 offset:8192
  ds_read_b64_tr_b16 v[136:137], v18 offset:8192
  ds_read_b64_tr_b16 v[138:139], v19 offset:8192
  ds_read_b64_tr_b16 v[140:141], v22 offset:8192
  ds_read_b64_tr_b16 v[142:143], v23 offset:8192
  v_mfma_f32_32x32x16_bf16 v[208:223], v[148:151], v[96:99], v[208:223]
  s_bfe_u32 s77, s80, 0x40018
  s_lshl_b32 s77, s77, 14
  s_add_u32 s77, s77, s72
  buffer_load_dwordx4 v[80:83], v5, s[44:47], s77 offen sc1
  v_mfma_f32_32x32x16_bf16 v[224:239], v[152:155], v[96:99], v[224:239]
  buffer_load_dwordx4 v[84:87], v5, s[44:47], s77 offen offset:1024 sc1
  v_mfma_f32_32x32x16_bf16 v[240:255], v[156:159], v[96:99], v[240:255]
  buffer_load_dwordx4 v[88:91], v5, s[44:47], s77 offen offset:2048 sc1
  s_waitcnt lgkmcnt(8)
  v_mfma_f32_32x32x16_bf16 v[192:207], v[160:163], v[100:103], v[192:207]
  ds_read_b64_tr_b16 v[144:145], v12 offset:8192
  ds_read_b64_tr_b16 v[146:147], v13 offset:8192
  ds_read_b64_tr_b16 v[148:149], v16 offset:8192
  ds_read_b64_tr_b16 v[150:151], v17 offset:8192
  ds_read_b64_tr_b16 v[152:153], v20 offset:8192
  ds_read_b64_tr_b16 v[154:155], v21 offset:8192
  ds_read_b64_tr_b16 v[156:157], v24 offset:8192
  ds_read_b64_tr_b16 v[158:159], v25 offset:8192
  v_mfma_f32_32x32x16_bf16 v[208:223], v[164:167], v[100:103], v[208:223]
  buffer_load_dwordx4 v[92:95], v5, s[44:47], s77 offen offset:3072 sc1
  v_mfma_f32_32x32x16_bf16 v[224:239], v[168:171], v[100:103], v[224:239]
  v_mfma_f32_32x32x16_bf16 v[240:255], v[172:175], v[100:103], v[240:255]
  s_waitcnt lgkmcnt(8)
  v_mfma_f32_32x32x16_bf16 v[192:207], v[128:131], v[104:107], v[192:207]
  v_mfma_f32_32x32x16_bf16 v[208:223], v[132:135], v[104:107], v[208:223]
  v_mfma_f32_32x32x16_bf16 v[224:239], v[136:139], v[104:107], v[224:239]
  v_mfma_f32_32x32x16_bf16 v[240:255], v[140:143], v[104:107], v[240:255]
  s_waitcnt lgkmcnt(0)
  v_add_u32 v10, 0xfffe0000, v10
  v_add_u32 v11, 0xfffe0000, v11
  v_add_u32 v12, 0xfffe0000, v12
  v_add_u32 v13, 0xfffe0000, v13
  v_add_u32 v14, 0xfffe0000, v14
  v_add_u32 v15, 0xfffe0000, v15
  v_add_u32 v16, 0xfffe0000, v16
  v_add_u32 v17, 0xfffe0000, v17
  v_add_u32 v18, 0xfffe0000, v18
  v_add_u32 v19, 0xfffe0000, v19
  v_add_u32 v20, 0xfffe0000, v20
  v_add_u32 v21, 0xfffe0000, v21
  v_add_u32 v22, 0xfffe0000, v22
  v_add_u32 v23, 0xfffe0000, v23
  v_add_u32 v24, 0xfffe0000, v24
  v_add_u32 v25, 0xfffe0000, v25
  s_cmp_lg_u32 s3, 0
  s_cbranch_scc1 L_op_rdy5
  s_mov_b32 s82, 262144
L_op_chk5:
  s_bfe_u32 s79, s80, 0x4001c
  s_bitcmp1_b32 s81, s79
  s_cbranch_scc1 L_op_rdy5
  s_sub_u32 s82, s82, 1
  s_cmp_eq_u32 s82, 0
  s_cbranch_scc1 L_op_rdy5
  buffer_load_dword v28, v34, s[64:67], s14 offen sc1
  s_waitcnt vmcnt(0)
  v_cmp_eq_u32 vcc, 1, v28
  s_nop 3
  s_lshr_b32 s77, vcc_lo, 8
  s_and_b32 s77, s77, vcc_lo
  s_and_b32 s77, s77, 0xff
  s_and_b32 s81, vcc_lo, 0xf0000
  s_or_b32 s81, s81, s77
  s_branch L_op_chk5
L_op_rdy5:
  s_waitcnt vmcnt(8)
  s_barrier
  ds_read_b64_tr_b16 v[160:161], v10 offset:0
  ds_read_b64_tr_b16 v[162:163], v11 offset:0
  ds_read_b64_tr_b16 v[164:165], v14 offset:0
  ds_read_b64_tr_b16 v[166:167], v15 offset:0
  ds_read_b64_tr_b16 v[168:169], v18 offset:0
  ds_read_b64_tr_b16 v[170:171], v19 offset:0
  ds_read_b64_tr_b16 v[172:173], v22 offset:0
  ds_read_b64_tr_b16 v[174:175], v23 offset:0
  v_mfma_f32_32x32x16_bf16 v[192:207], v[144:147], v[108:111], v[192:207]
  v_mfma_f32_32x32x16_bf16 v[208:223], v[148:151], v[108:111], v[208:223]
  ds_read_b64_tr_b16 v[128:129], v12 offset:0
  ds_read_b64_tr_b16 v[130:131], v13 offset:0
  ds_read_b64_tr_b16 v[132:133], v16 offset:0
  ds_read_b64_tr_b16 v[134:135], v17 offset:0
  ds_read_b64_tr_b16 v[136:137], v20 offset:0
  ds_read_b64_tr_b16 v[138:139], v21 offset:0
  ds_read_b64_tr_b16 v[140:141], v24 offset:0
  ds_read_b64_tr_b16 v[142:143], v25 offset:0
  v_mfma_f32_32x32x16_bf16 v[224:239], v[152:155], v[108:111], v[224:239]
  v_mfma_f32_32x32x16_bf16 v[240:255], v[156:159], v[108:111], v[240:255]
  s_waitcnt lgkmcnt(8)
  v_mfma_f32_32x32x16_bf16 v[192:207], v[160:163], v[112:115], v[192:207]
  ds_read_b64_tr_b16 v[144:145], v10 offset:8192
  ds_read_b64_tr_b16 v[146:147], v11 offset:8192
  ds_read_b64_tr_b16 v[148:149], v14 offset:8192
  ds_read_b64_tr_b16 v[150:151], v15 offset:8192
  ds_read_b64_tr_b16 v[152:153], v18 offset:8192
  ds_read_b64_tr_b16 v[154:155], v19 offset:8192
  ds_read_b64_tr_b16 v[156:157], v22 offset:8192
  ds_read_b64_tr_b16 v[158:159], v23 offset:8192
  v_mfma_f32_32x32x16_bf16 v[208:223], v[164:167], v[112:115], v[208:223]
  s_bfe_u32 s77, s80, 0x4001c
  s_lshl_b32 s77, s77, 14
  s_add_u32 s77, s77, s72
  buffer_load_dwordx4 v[96:99], v5, s[44:47], s77 offen sc1
  v_mfma_f32_32x32x16_bf16 v[224:239], v[168:171], v[112:115], v[224:239]
  buffer_load_dwordx4 v[100:103], v5, s[44:47], s77 offen offset:1024 sc1
  v_mfma_f32_32x32x16_bf16 v[240:255], v[172:175], v[112:115], v[240:255]
  buffer_load_dwordx4 v[104:107], v5, s[44:47], s77 offen offset:2048 sc1
  s_waitcnt lgkmcnt(8)
  v_mfma_f32_32x32x16_bf16 v[192:207], v[128:131], v[116:119], v[192:207]
  ds_read_b64_tr_b16 v[160:161], v12 offset:8192
  ds_read_b64_tr_b16 v[162:163], v13 offset:8192
  ds_read_b64_tr_b16 v[164:165], v16 offset:8192
  ds_read_b64_tr_b16 v[166:167], v17 offset:8192
  ds_read_b64_tr_b16 v[168:169], v20 offset:8192
  ds_read_b64_tr_b16 v[170:171], v21 offset:8192
  ds_read_b64_tr_b16 v[172:173], v24 offset:8192
  ds_read_b64_tr_b16 v[174:175], v25 offset:8192
  v_mfma_f32_32x32x16_bf16 v[208:223], v[132:135], v[116:119], v[208:223]
  buffer_load_dwordx4 v[108:111], v5, s[44:47], s77 offen offset:3072 sc1
  v_mfma_f32_32x32x16_bf16 v[224:239], v[136:139], v[116:119], v[224:239]
  v_mfma_f32_32x32x16_bf16 v[240:255], v[140:143], v[116:119], v[240:255]
  s_waitcnt lgkmcnt(8)
  v_mfma_f32_32x32x16_bf16 v[192:207], v[144:147], v[120:123], v[192:207]
  v_mfma_f32_32x32x16_bf16 v[208:223], v[148:151], v[120:123], v[208:223]
  v_mfma_f32_32x32x16_bf16 v[224:239], v[152:155], v[120:123], v[224:239]
  v_mfma_f32_32x32x16_bf16 v[240:255], v[156:159], v[120:123], v[240:255]
  s_waitcnt lgkmcnt(0)
  s_waitcnt vmcnt(4)
  s_barrier
  ds_read_b64_tr_b16 v[128:129], v10 offset:32768
  ds_read_b64_tr_b16 v[130:131], v11 offset:32768
  ds_read_b64_tr_b16 v[132:133], v14 offset:32768
  ds_read_b64_tr_b16 v[134:135], v15 offset:32768
  ds_read_b64_tr_b16 v[136:137], v18 offset:32768
  ds_read_b64_tr_b16 v[138:139], v19 offset:32768
  ds_read_b64_tr_b16 v[140:141], v22 offset:32768
  ds_read_b64_tr_b16 v[142:143], v23 offset:32768
  v_mfma_f32_32x32x16_bf16 v[192:207], v[160:163], v[124:127], v[192:207]
  v_mfma_f32_32x32x16_bf16 v[208:223], v[164:167], v[124:127], v[208:223]
  ds_read_b64_tr_b16 v[144:145], v12 offset:32768
  ds_read_b64_tr_b16 v[146:147], v13 offset:32768
  ds_read_b64_tr_b16 v[148:149], v16 offset:32768
  ds_read_b64_tr_b16 v[150:151], v17 offset:32768
  ds_read_b64_tr_b16 v[152:153], v20 offset:32768
  ds_read_b64_tr_b16 v[154:155], v21 offset:32768
  ds_read_b64_tr_b16 v[156:157], v24 offset:32768
  ds_read_b64_tr_b16 v[158:159], v25 offset:32768
  v_mfma_f32_32x32x16_bf16 v[224:239], v[168:171], v[124:127], v[224:239]
  v_mfma_f32_32x32x16_bf16 v[240:255], v[172:175], v[124:127], v[240:255]
  s_waitcnt lgkmcnt(8)
  v_mfma_f32_32x32x16_bf16 v[192:207], v[128:131], v[80:83], v[192:207]
  ds_read_b64_tr_b16 v[160:161], v10 offset:40960
  ds_read_b64_tr_b16 v[162:163], v11 offset:40960
  ds_read_b64_tr_b16 v[164:165], v14 offset:40960
  ds_read_b64_tr_b16 v[166:167], v15 offset:40960
  ds_read_b64_tr_b16 v[168:169], v18 offset:40960
  ds_read_b64_tr_b16 v[170:171], v19 offset:40960
  ds_read_b64_tr_b16 v[172:173], v22 offset:40960
  ds_read_b64_tr_b16 v[174:175], v23 offset:40960
  v_mfma_f32_32x32x16_bf16 v[208:223], v[132:135], v[80:83], v[208:223]
  v_mfma_f32_32x32x16_bf16 v[224:239], v[136:139], v[80:83], v[224:239]
  v_mfma_f32_32x32x16_bf16 v[240:255], v[140:143], v[80:83], v[240:255]
  s_waitcnt lgkmcnt(8)
  v_mfma_f32_32x32x16_bf16 v[192:207], v[144:147], v[84:87], v[192:207]
  ds_read_b64_tr_b16 v[128:129], v12 offset:40960
  ds_read_b64_tr_b16 v[130:131], v13 offset:40960
  ds_read_b64_tr_b16 v[132:133], v16 offset:40960
  ds_read_b64_tr_b16 v[134:135], v17 offset:40960
  ds_read_b64_tr_b16 v[136:137], v20 offset:40960
  ds_read_b64_tr_b16 v[138:139], v21 offset:40960
  ds_read_b64_tr_b16 v[140:141], v24 offset:40960
  ds_read_b64_tr_b16 v[142:143], v25 offset:40960
  v_mfma_f32_32x32x16_bf16 v[208:223], v[148:151], v[84:87], v[208:223]
  v_mfma_f32_32x32x16_bf16 v[224:239], v[152:155], v[84:87], v[224:239]
  v_mfma_f32_32x32x16_bf16 v[240:255], v[156:159], v[84:87], v[240:255]
  s_waitcnt lgkmcnt(8)
  v_mfma_f32_32x32x16_bf16 v[192:207], v[160:163], v[88:91], v[192:207]
  v_mfma_f32_32x32x16_bf16 v[208:223], v[164:167], v[88:91], v[208:223]
  v_mfma_f32_32x32x16_bf16 v[224:239], v[168:171], v[88:91], v[224:239]
  v_mfma_f32_32x32x16_bf16 v[240:255], v[172:175], v[88:91], v[240:255]
  s_waitcnt lgkmcnt(0)
  v_add_u32 v10, 0x10000, v10
  v_add_u32 v11, 0x10000, v11
  v_add_u32 v12, 0x10000, v12
  v_add_u32 v13, 0x10000, v13
  v_add_u32 v14, 0x10000, v14
  v_add_u32 v15, 0x10000, v15
  v_add_u32 v16, 0x10000, v16
  v_add_u32 v17, 0x10000, v17
  v_add_u32 v18, 0x10000, v18
  v_add_u32 v19, 0x10000, v19
  v_add_u32 v20, 0x10000, v20
  v_add_u32 v21, 0x10000, v21
  v_add_u32 v22, 0x10000, v22
  v_add_u32 v23, 0x10000, v23
  v_add_u32 v24, 0x10000, v24
  v_add_u32 v25, 0x10000, v25
  s_waitcnt vmcnt(0)
  s_barrier
  ds_read_b64_tr_b16 v[144:145], v10 offset:0
  ds_read_b64_tr_b16 v[146:147], v11 offset:0
  ds_read_b64_tr_b16 v[148:149], v14 offset:0
  ds_read_b64_tr_b16 v[150:151], v15 offset:0
  ds_read_b64_tr_b16 v[152:153], v18 offset:0
  ds_read_b64_tr_b16 v[154:155], v19 offset:0
  ds_read_b64_tr_b16 v[156:157], v22 offset:0
  ds_read_b64_tr_b16 v[158:159], v23 offset:0
  v_mfma_f32_32x32x16_bf16 v[192:207], v[128:131], v[92:95], v[192:207]
  v_mfma_f32_32x32x16_bf16 v[208:223], v[132:135], v[92:95], v[208:223]
  ds_read_b64_tr_b16 v[160:161], v12 offset:0
  ds_read_b64_tr_b16 v[162:163], v13 offset:0
  ds_read_b64_tr_b16 v[164:165], v16 offset:0
  ds_read_b64_tr_b16 v[166:167], v17 offset:0
  ds_read_b64_tr_b16 v[168:169], v20 offset:0
  ds_read_b64_tr_b16 v[170:171], v21 offset:0
  ds_read_b64_tr_b16 v[172:173], v24 offset:0
  ds_read_b64_tr_b16 v[174:175], v25 offset:0
  v_mfma_f32_32x32x16_bf16 v[224:239], v[136:139], v[92:95], v[224:239]
  v_mfma_f32_32x32x16_bf16 v[240:255], v[140:143], v[92:95], v[240:255]
  s_waitcnt lgkmcnt(8)
  v_mfma_f32_32x32x16_bf16 v[192:207], v[144:147], v[96:99], v[192:207]
  ds_read_b64_tr_b16 v[128:129], v10 offset:8192
  ds_read_b64_tr_b16 v[130:131], v11 offset:8192
  ds_read_b64_tr_b16 v[132:133], v14 offset:8192
  ds_read_b64_tr_b16 v[134:135], v15 offset:8192
  ds_read_b64_tr_b16 v[136:137], v18 offset:8192
  ds_read_b64_tr_b16 v[138:139], v19 offset:8192
  ds_read_b64_tr_b16 v[140:141], v22 offset:8192
  ds_read_b64_tr_b16 v[142:143], v23 offset:8192
  v_mfma_f32_32x32x16_bf16 v[208:223], v[148:151], v[96:99], v[208:223]
  v_mfma_f32_32x32x16_bf16 v[224:239], v[152:155], v[96:99], v[224:239]
  v_mfma_f32_32x32x16_bf16 v[240:255], v[156:159], v[96:99], v[240:255]
  s_waitcnt lgkmcnt(8)
  v_mfma_f32_32x32x16_bf16 v[192:207], v[160:163], v[100:103], v[192:207]
  ds_read_b64_tr_b16 v[144:145], v12 offset:8192
  ds_read_b64_tr_b16 v[146:147], v13 offset:8192
  ds_read_b64_tr_b16 v[148:149], v16 offset:8192
  ds_read_b64_tr_b16 v[150:151], v17 offset:8192
  ds_read_b64_tr_b16 v[152:153], v20 offset:8192
  ds_read_b64_tr_b16 v[154:155], v21 offset:8192
  ds_read_b64_tr_b16 v[156:157], v24 offset:8192
  ds_read_b64_tr_b16 v[158:159], v25 offset:8192
  v_mfma_f32_32x32x16_bf16 v[208:223], v[164:167], v[100:103], v[208:223]
  v_mfma_f32_32x32x16_bf16 v[224:239], v[168:171], v[100:103], v[224:239]
  v_mfma_f32_32x32x16_bf16 v[240:255], v[172:175], v[100:103], v[240:255]
  s_waitcnt lgkmcnt(8)
  v_mfma_f32_32x32x16_bf16 v[192:207], v[128:131], v[104:107], v[192:207]
  v_mfma_f32_32x32x16_bf16 v[208:223], v[132:135], v[104:107], v[208:223]
  v_mfma_f32_32x32x16_bf16 v[224:239], v[136:139], v[104:107], v[224:239]
  v_mfma_f32_32x32x16_bf16 v[240:255], v[140:143], v[104:107], v[240:255]
  s_waitcnt lgkmcnt(0)
  v_mfma_f32_32x32x16_bf16 v[192:207], v[144:147], v[108:111], v[192:207]
  v_mfma_f32_32x32x16_bf16 v[208:223], v[148:151], v[108:111], v[208:223]
  v_mfma_f32_32x32x16_bf16 v[224:239], v[152:155], v[108:111], v[224:239]
  v_mfma_f32_32x32x16_bf16 v[240:255], v[156:159], v[108:111], v[240:255]
  s_nop 15
  s_nop 3
  s_barrier
  s_cmp_eq_u32 s6, 1
  s_cbranch_scc1 L_op_kh1
  ds_write_b128 v36, v[224:227] offset:0
  ds_write_b128 v36, v[228:231] offset:1024
  ds_write_b128 v36, v[232:235] offset:2048
  ds_write_b128 v36, v[236:239] offset:3072
  ds_write_b128 v36, v[240:243] offset:4096
  ds_write_b128 v36, v[244:247] offset:5120
  ds_write_b128 v36, v[248:251] offset:6144
  ds_write_b128 v36, v[252:255] offset:7168
  s_branch L_op_khd
L_op_kh1:
  ds_write_b128 v36, v[192:195] offset:0
  ds_write_b128 v36, v[196:199] offset:1024
  ds_write_b128 v36, v[200:203] offset:2048
  ds_write_b128 v36, v[204:207] offset:3072
  ds_write_b128 v36, v[208:211] offset:4096
  ds_write_b128 v36, v[212:215] offset:5120
  ds_write_b128 v36, v[216:219] offset:6144
  ds_write_b128 v36, v[220:223] offset:7168
  s_waitcnt lgkmcnt(0)
  v_mov_b32 v192, v224
  v_mov_b32 v193, v225
  v_mov_b32 v194, v226
  v_mov_b32 v195, v227
  v_mov_b32 v196, v228
  v_mov_b32 v197, v229
  v_mov_b32 v198, v230
  v_mov_b32 v199, v231
  v_mov_b32 v200, v232
  v_mov_b32 v201, v233
  v_mov_b32 v202, v234
  v_mov_b32 v203, v235
  v_mov_b32 v204, v236
  v_mov_b32 v205, v237
  v_mov_b32 v206, v238
  v_mov_b32 v207, v239
  v_mov_b32 v208, v240
  v_mov_b32 v209, v241
  v_mov_b32 v210, v242
  v_mov_b32 v211, v243
  v_mov_b32 v212, v244
  v_mov_b32 v213, v245
  v_mov_b32 v214, v246
  v_mov_b32 v215, v247
  v_mov_b32 v216, v248
  v_mov_b32 v217, v249
  v_mov_b32 v218, v250
  v_mov_b32 v219, v251
  v_mov_b32 v220, v252
  v_mov_b32 v221, v253
  v_mov_b32 v222, v254
  v_mov_b32 v223, v255
L_op_khd:
  s_lshl_b32 s79, s85, 5
  s_add_u32 s79, s79, s8
  s_lshl_b32 s79, s79, 18
  s_lshl_b32 s77, s15, 16
  s_add_u32 s77, s77, s79
  s_lshl_b32 s78, s86, 14
  s_add_u32 s77, s77, s78
  s_lshl_b32 s78, s6, 13
  s_add_u32 s77, s77, s78
  s_add_u32 s78, s77, 4096
  s_waitcnt lgkmcnt(0)
  s_barrier
  ds_read_b128 v[128:131], v37 offset:0
  ds_read_b128 v[132:135], v37 offset:1024
  ds_read_b128 v[136:139], v37 offset:2048
  ds_read_b128 v[140:143], v37 offset:3072
  ds_read_b128 v[144:147], v37 offset:4096
  ds_read_b128 v[148:151], v37 offset:5120
  ds_read_b128 v[152:155], v37 offset:6144
  ds_read_b128 v[156:159], v37 offset:7168
  s_waitcnt lgkmcnt(7)
  v_add_f32 v192, v192, v128
  v_add_f32 v193, v193, v129
  v_add_f32 v194, v194, v130
  v_add_f32 v195, v195, v131
  buffer_store_dwordx4 v[192:195], v5, s[56:59], s77 offen offset:0 sc1
  s_waitcnt lgkmcnt(6)
  v_add_f32 v196, v196, v132
  v_add_f32 v197, v197, v133
  v_add_f32 v198, v198, v134
  v_add_f32 v199, v199, v135
  buffer_store_dwordx4 v[196:199], v5, s[56:59], s77 offen offset:1024 sc1
  s_waitcnt lgkmcnt(5)
  v_add_f32 v200, v200, v136
  v_add_f32 v201, v201, v137
  v_add_f32 v202, v202, v138
  v_add_f32 v203, v203, v139
  buffer_store_dwordx4 v[200:203], v5, s[56:59], s77 offen offset:2048 sc1
  s_waitcnt lgkmcnt(4)
  v_add_f32 v204, v204, v140
  v_add_f32 v205, v205, v141
  v_add_f32 v206, v206, v142
  v_add_f32 v207, v207, v143
  buffer_store_dwordx4 v[204:207], v5, s[56:59], s77 offen offset:3072 sc1
  s_waitcnt lgkmcnt(3)
  v_add_f32 v208, v208, v144
  v_add_f32 v209, v209, v145
  v_add_f32 v210, v210, v146
  v_add_f32 v211, v211, v147
  buffer_store_dwordx4 v[208:211], v5, s[56:59], s78 offen offset:0 sc1
  s_waitcnt lgkmcnt(2)
  v_add_f32 v212, v212, v148
  v_add_f32 v213, v213, v149
  v_add_f32 v214, v214, v150
  v_add_f32 v215, v215, v151
  buffer_store_dwordx4 v[212:215], v5, s[56:59], s78 offen offset:1024 sc1
  s_waitcnt lgkmcnt(1)
  v_add_f32 v216, v216, v152
  v_add_f32 v217, v217, v153
  v_add_f32 v218, v218, v154
  v_add_f32 v219, v219, v155
  buffer_store_dwordx4 v[216:219], v5, s[56:59], s78 offen offset:2048 sc1
  s_waitcnt lgkmcnt(0)
  v_add_f32 v220, v220, v156
  v_add_f32 v221, v221, v157
  v_add_f32 v222, v222, v158
  v_add_f32 v223, v223, v159
  buffer_store_dwordx4 v[220:223], v5, s[56:59], s78 offen offset:3072 sc1
  s_lshl_b32 s77, s86, 16
  s_add_u32 s79, s79, s77
  s_lshl_b32 s77, s3, 11
  s_add_u32 s79, s79, s77
  s_mov_b32 s72, s79
  s_lshl_b32 s73, s87, 19
  s_lshl_b32 s77, s86, 17
  s_add_u32 s73, s73, s77
  s_lshl_b32 s77, s85, 11
  s_add_u32 s73, s73, s77
  s_lshl_b32 s77, s13, 8
  s_add_u32 s73, s73, s77
  s_lshr_b32 s77, s3, 1
  s_lshl_b32 s77, s77, 6
  s_add_u32 s73, s73, s77
  s_and_b32 s77, s3, 1
  s_lshl_b32 s77, s77, 4
  s_add_u32 s73, s73, s77
  s_waitcnt vmcnt(0)
  s_barrier
  s_cmp_lg_u32 s3, 0
  s_cbranch_scc1 L_op_fin
  s_mov_b64 exec, 0xf
  buffer_store_dword v33, v39, s[64:67], 0 offen sc1
  s_mov_b64 exec, -1
  s_mov_b32 s82, 262144
L_op_poll2:
  buffer_load_dword v28, v34, s[64:67], s14 offen sc1
  s_waitcnt vmcnt(0)
  v_cmp_eq_u32 vcc, 1, v28
  s_nop 3
  s_lshr_b32 s77, vcc_lo, 8
  s_and_b32 s77, s77, vcc_lo
  s_and_b32 s77, s77, 0xff
  s_and_b32 s81, vcc_lo, 0xf0000
  s_or_b32 s81, s81, s77
  s_lshr_b32 s77, s81, 16
  s_cmp_eq_u32 s77, 15
  s_cbranch_scc1 L_op_fin
  s_sub_u32 s82, s82, 1
  s_cmp_eq_u32 s82, 0
  s_cbranch_scc1 L_op_fin
  s_sleep 2
  s_branch L_op_poll2
L_op_fin:
  s_barrier
  buffer_load_dwordx4 v[128:131], v5, s[56:59], s72 offen offset:0 sc1
  buffer_load_dwordx4 v[132:135], v5, s[56:59], s72 offen offset:1024 sc1
  s_add_u32 s72, s72, 16384
  buffer_load_dwordx4 v[136:139], v5, s[56:59], s72 offen offset:0 sc1
  buffer_load_dwordx4 v[140:143], v5, s[56:59], s72 offen offset:1024 sc1
  s_add_u32 s72, s72, 16384
  buffer_load_dwordx4 v[144:147], v5, s[56:59], s72 offen offset:0 sc1
  buffer_load_dwordx4 v[148:151], v5, s[56:59], s72 offen offset:1024 sc1
  s_add_u32 s72, s72, 16384
  buffer_load_dwordx4 v[152:155], v5, s[56:59], s72 offen offset:0 sc1
  buffer_load_dwordx4 v[156:159], v5, s[56:59], s72 offen offset:1024 sc1
  s_waitcnt vmcnt(0)
  v_add_f32 v128, v128, v136
  v_add_f32 v144, v144, v152
  v_add_f32 v129, v129, v137
  v_add_f32 v145, v145, v153
  v_add_f32 v130, v130, v138
  v_add_f32 v146, v146, v154
  v_add_f32 v131, v131, v139
  v_add_f32 v147, v147, v155
  v_add_f32 v132, v132, v140
  v_add_f32 v148, v148, v156
  v_add_f32 v133, v133, v141
  v_add_f32 v149, v149, v157
  v_add_f32 v134, v134, v142
  v_add_f32 v150, v150, v158
  v_add_f32 v135, v135, v143
  v_add_f32 v151, v151, v159
  v_add_f32 v128, v128, v144
  v_add_f32 v129, v129, v145
  v_add_f32 v130, v130, v146
  v_add_f32 v131, v131, v147
  v_add_f32 v132, v132, v148
  v_add_f32 v133, v133, v149
  v_add_f32 v134, v134, v150
  v_add_f32 v135, v135, v151
  v_cvt_pk_bf16_f32 v160, v128, v129
  v_cvt_pk_bf16_f32 v161, v130, v131
  v_cvt_pk_bf16_f32 v162, v132, v133
  v_cvt_pk_bf16_f32 v163, v134, v135
  buffer_store_dwordx4 v[160:163], v38, s[52:55], s73 offen
L_k1_end:
  s_endpgm
.section .rodata,"a"
.p2align 6
.amdhsa_kernel concat_heads__gqa_block_cached__mha_block_cached__near_ridge_kernel
  .amdhsa_next_free_vgpr 256
  .amdhsa_next_free_sgpr 102
  .amdhsa_accum_offset 256
  .amdhsa_group_segment_fixed_size 0
  .amdhsa_kernarg_size 104
  .amdhsa_user_sgpr_count 2
  .amdhsa_user_sgpr_kernarg_segment_ptr 1
  .amdhsa_system_sgpr_workgroup_id_x 1
.end_amdhsa_kernel
```
